```python
import torch

def _softmax(x, axis=-1):
    return torch.softmax(x, dim=axis)
def _gelu(x):
    return torch.nn.functional.gelu(x, approximate="tanh")
def _silu(x):
    return torch.nn.functional.silu(x)
def _sigmoid(x):
    return torch.sigmoid(x)
def _layernorm(x, axis=-1, eps=1e-5):
    m = x.mean(dim=axis, keepdim=True)
    v = x.var(dim=axis, keepdim=True, unbiased=False)
    return (x - m) / torch.sqrt(v + eps)
def _scatter_add(tgt, idx, src, axis=0):
    return tgt.clone().index_add_(axis, idx, src)
def _segment_sum(src, seg, n):
    out = torch.zeros((n,) + src.shape[1:], dtype=src.dtype)
    return out.index_add_(0, seg, src)
def _pad(x, pw):
    flat = tuple(v for pair in reversed(pw) for v in pair)
    return torch.nn.functional.pad(x, flat)

kernel_name = 'recurrent_scan__mha_block_cached__glu_gated_reglu__decode'

def setup_inputs():

    _w = (lambda a: (lambda t: t.to(torch.bfloat16) if t.is_floating_point() else t)(torch.as_tensor(a)))
    def _A_setup():
        B, Sq, D = 4, 1, 512
        H, Sk, Dh = 32, 4096, 128
        return {
            "x": _w((lambda *s: torch.randn(*s, dtype=torch.bfloat16) * 0.05)(B, Sq, D)),
            "k_cache": _w((lambda *s: torch.randn(*s, dtype=torch.bfloat16) * 3.2)(B, H, Sk, Dh)),
            "v_cache": _w((lambda *s: torch.randn(*s, dtype=torch.bfloat16) * 3.2)(B, H, Sk, Dh)),
            "wq": _w((lambda *s: torch.randn(*s, dtype=torch.bfloat16) * 3.2)(D, H * Dh) * (D ** -0.5)),
            "wo": _w((lambda *s: torch.randn(*s, dtype=torch.bfloat16) * 3.2)(H * Dh, D) * ((H * Dh) ** -0.5)),
        }
    _A_in = _A_setup()

    def _B_setup():
        B, S, D, F = 4, 1, 512, 1792
        return {
            "x": _w((lambda *s: torch.randn(*s, dtype=torch.bfloat16) * 0.05)(B, S, D)),
            "W_gate": _w((lambda *s: torch.randn(*s, dtype=torch.bfloat16) * 0.4)(D, F) * (2.0 / D) ** 0.5),
            "W_up": _w((lambda *s: torch.randn(*s, dtype=torch.bfloat16) * 0.4)(D, F) * (2.0 / D) ** 0.5),
            "W_down": _w((lambda *s: torch.randn(*s, dtype=torch.bfloat16) * 0.4)(F, D) * (1.0 / F) ** 0.5),
        }
    _B_in = _B_setup()

    return {
        "A_x": _A_in["x"],
        "A_k_cache": _A_in["k_cache"],
        "A_v_cache": _A_in["v_cache"],
        "A_wq": _A_in["wq"],
        "A_wo": _A_in["wo"],
        "B_x": _B_in["x"],
        "B_W_gate": _B_in["W_gate"],
        "B_W_up": _B_in["W_up"],
        "B_W_down": _B_in["W_down"],
    }

def reference(A_x, A_k_cache, A_v_cache, A_wq, A_wo, B_x, B_W_gate, B_W_up, B_W_down):
    def _A_ref(x, k_cache, v_cache, wq, wo):
        B, Sq, D = x.shape
        H, Dh = 32, 128
        q = (lambda x, *d: x.permute(*d))((x @ wq).reshape(B, Sq, H, Dh), 0, 2, 1, 3)
        scores = torch.einsum("bhqd,bhkd->bhqk", q, k_cache) * (Dh ** -0.5)
        p = _softmax(scores, axis=-1)
        o = torch.einsum("bhqk,bhkd->bhqd", p, v_cache)
        return (lambda x, *d: x.permute(*d))(o, 0, 2, 1, 3).reshape(B, Sq, H * Dh) @ wo

    def _B_ref(x, W_gate, W_up, W_down):
        gate = torch.einsum("bsd,df->bsf", x, W_gate)
        up = torch.einsum("bsd,df->bsf", x, W_up)
        gate = gate * (lambda x, dt: x.to(dt))(gate > 0, gate.dtype)
        h = gate * up
        return torch.einsum("bsf,fd->bsd", h, W_down)

    x = A_x
    xn = _layernorm(x, axis=-1)
    s = _A_ref(xn, A_k_cache, A_v_cache, A_wq, A_wo)
    g = _silu(_B_ref(xn, B_W_gate, B_W_up, B_W_down))
    return x + s * g
```

```asm
; @launch grid=(256,1,1) block=(512,1,1) lds=152064
.amdgcn_target "amdgcn-amd-amdhsa--gfx950"
.text
.globl recurrent_scan__mha_block_cached__glu_gated_reglu__decode_kernel
.p2align 8
.type recurrent_scan__mha_block_cached__glu_gated_reglu__decode_kernel,@function
recurrent_scan__mha_block_cached__glu_gated_reglu__decode_kernel:
    s_load_dwordx16 s[4:19], s[0:1], 0
    s_load_dwordx8 s[20:27], s[0:1], 64
    s_cmp_ge_u32 s2, 0x100
    s_cbranch_scc1 L_end
    v_lshrrev_b32 v1, 6, v0
    v_and_b32 v0, 63, v0
    v_readfirstlane_b32 s3, v1
    s_and_b32 s28, s2, 7
    s_lshr_b32 s29, s2, 3
    s_and_b32 s30, s29, 24
    s_add_u32 s30, s30, s28
    s_bfe_u32 s31, s29, 0x20001
    s_and_b32 s32, s29, 1
    s_lshl_b32 s33, s31, 5
    s_add_u32 s33, s33, s30
    v_lshrrev_b32 v1, 4, v0
    v_and_b32 v2, 15, v0
    v_lshlrev_b32 v2, 2, v2
    v_mov_b32 v3, -1
    ds_write_b32 v2, v3 offset:4096
    s_cmp_ge_u32 s3, 4
    s_cbranch_scc1 L_h0
    s_lshl2_add_u32 s50, s29, s3
    s_and_b32 s51, s50, 31
    s_lshl_b32 s64, s30, 5
    s_add_u32 s64, s64, s51
    s_lshl_b32 s64, s64, 12
    s_lshl_b32 s65, s28, 7
    s_add_u32 s65, s65, s50
    s_mul_i32 s65, s65, 1792
    v_lshlrev_b32 v13, 6, v0
    v_mul_u32_u24 v15, 28, v0
    s_waitcnt lgkmcnt(0)
    s_mov_b32 s56, s12
    s_and_b32 s57, s13, 0xffff
    s_mov_b32 s58, 4194304
    s_mov_b32 s59, 0x20000
    buffer_load_dword v14, v13, s[56:59], s64 offen
    s_mov_b32 s52, s20
    s_and_b32 s53, s21, 0xffff
    s_mov_b32 s54, 1835008
    s_mov_b32 s55, 0x20000
    buffer_load_dword v12, v15, s[52:55], s65 offen
    s_lshl_b32 s60, s33, 20
    s_lshl_b32 s61, s32, 15
    s_add_u32 s60, s60, s61
    s_sub_u32 s61, 0x100000, s61
    s_lshl_b32 s35, s3, 8
    v_and_b32 v2, 3, v0
    v_lshlrev_b32 v2, 4, v2
    v_lshl_add_u32 v2, v1, 6, v2
    v_bfe_u32 v3, v0, 2, 2
    v_lshl_add_u32 v2, v3, 12, v2
    v_add_u32 v2, s35, v2
    s_add_u32 s36, s6, s60
    s_addc_u32 s37, s7, 0
    s_and_b32 s37, s37, 0xffff
    s_mov_b32 s38, s61
    s_mov_b32 s39, 0x20000
    s_mov_b32 s44, 0
    buffer_load_dwordx4 v[80:83], v2, s[36:39], s44 offen offset:0 nt
    s_barrier
    s_branch L_s1
L_h0:
    s_sub_u32 s35, s3, 4
    s_and_b32 s34, s29, 7
    s_lshl_b32 s34, s34, 2
    v_and_b32 v2, 15, v0
    v_lshl_add_u32 v3, v2, 1, s34
    v_and_b32 v3, 31, v3
    v_lshl_add_u32 v3, v1, 5, v3
    s_lshl_b32 s45, s35, 8
    v_lshl_add_u32 v4, v3, 1, s45
    v_lshlrev_b32 v5, 4, v0
    s_lshl_b32 s46, s35, 20
    v_lshlrev_b32 v6, 18, v1
    v_lshl_add_u32 v6, v2, 4, v6
    v_add_u32 v6, s46, v6
    s_lshl_b32 s47, s31, 10
    s_lshl_b32 s60, s30, 8
    s_sub_u32 s61, 0x400000, s60
    s_lshl_b32 s44, s34, 13
    s_waitcnt lgkmcnt(0)
    s_mov_b32 s36, s4
    s_and_b32 s37, s5, 0xffff
    s_mov_b32 s38, 4096
    s_mov_b32 s39, 0x20000
    s_add_u32 s40, s10, s60
    s_addc_u32 s41, s11, 0
    s_and_b32 s41, s41, 0xffff
    s_mov_b32 s42, s61
    s_mov_b32 s43, 0x20000
    buffer_load_dwordx4 v[28:31], v5, s[36:39], s47 offen
    buffer_load_dword v7, v4, s[36:39], s47 offen
    buffer_load_dwordx4 v[128:131], v6, s[40:43], s44 offen
    s_add_u32 s44, s44, 0x2000
    s_and_b32 s44, s44, 0x3ffff
    buffer_load_dwordx4 v[132:135], v6, s[40:43], s44 offen
    s_add_u32 s44, s44, 0x2000
    s_and_b32 s44, s44, 0x3ffff
    buffer_load_dwordx4 v[136:139], v6, s[40:43], s44 offen
    s_add_u32 s44, s44, 0x2000
    s_and_b32 s44, s44, 0x3ffff
    s_add_u32 s48, s26, 1179648
    s_addc_u32 s49, s27, 0
    s_load_dword s74, s[48:49], 0
    s_barrier
    s_branch L_h1
L_s1:
    s_add_u32 s40, s8, s60
    s_addc_u32 s41, s9, 0
    s_and_b32 s41, s41, 0xffff
    s_mov_b32 s42, s61
    s_mov_b32 s43, 0x20000
    v_and_b32 v3, 15, v0
    v_lshl_add_u32 v3, v3, 4, s35
    v_lshl_add_u32 v3, v1, 12, v3
    v_and_b32 v8, 1, v0
    v_lshlrev_b32 v8, 4, v8
    v_mov_b32 v19, 0xffff
    v_lshlrev_b32 v8, v8, v19
    v_bfe_u32 v19, v0, 1, 3
    v_cmp_eq_u32 vcc, 0, v19
    s_nop 1
    v_cndmask_b32 v16, 0, v8, vcc
    v_cmp_eq_u32 vcc, 1, v19
    s_nop 1
    v_cndmask_b32 v17, 0, v8, vcc
    v_cmp_eq_u32 vcc, 2, v19
    s_nop 1
    v_cndmask_b32 v18, 0, v8, vcc
    v_cmp_eq_u32 vcc, 3, v19
    s_nop 1
    v_cndmask_b32 v19, 0, v8, vcc
    v_mov_b32 v32, 0
    v_mov_b32 v33, 0
    v_mov_b32 v34, 0
    v_mov_b32 v35, 0
    v_mov_b32 v36, 0
    v_mov_b32 v37, 0
    v_mov_b32 v38, 0
    v_mov_b32 v39, 0
    v_mov_b32 v40, 0
    v_mov_b32 v41, 0
    v_mov_b32 v42, 0
    v_mov_b32 v43, 0
    v_mov_b32 v44, 0
    v_mov_b32 v45, 0
    v_mov_b32 v46, 0
    v_mov_b32 v47, 0
    v_mov_b32 v10, 0xff800000
    v_mov_b32 v11, 0
    v_and_b32 v4, 3, v0
    v_lshl_add_u32 v4, v1, 2, v4
    v_lshlrev_b32 v4, 5, v4
    v_and_b32 v5, 12, v0
    v_lshlrev_b32 v5, 4, v5
    v_and_b32 v8, 1, v0
    v_lshl_add_u32 v5, v8, 5, v5
    v_lshl_add_u32 v5, v1, 3, v5
    v_bfe_u32 v8, v0, 1, 1
    v_lshl_add_u32 v5, v8, 2, v5
    s_mul_i32 s46, s3, 272
    s_add_u32 s46, s46, 2048
    v_add_u32 v5, s46, v5
    s_lshl_b32 s46, s3, 3
    s_add_u32 s46, s46, 4096
    v_mov_b32 v6, s46
    s_mov_b32 s47, 1035273459
    s_mov_b32 s48, 1069066811
    s_add_u32 s72, s26, 1179648
    s_addc_u32 s73, s27, 0
    s_load_dword s74, s[72:73], 0
    s_mul_i32 s49, s3, 20480
    s_add_u32 s49, s49, 70144
    v_lshl_add_u32 v7, v0, 4, s49
    buffer_load_dwordx4 v[84:87], v2, s[36:39], s44 offen offset:1024 nt
    buffer_load_dwordx4 v[88:91], v2, s[36:39], s44 offen offset:2048 nt
    buffer_load_dwordx4 v[92:95], v2, s[36:39], s44 offen offset:3072 nt
    s_mov_b32 s44, 16384
    buffer_load_dwordx4 v[96:99], v2, s[36:39], s44 offen offset:0 nt
    s_waitcnt vmcnt(4)
    buffer_load_dwordx4 v[100:103], v2, s[36:39], s44 offen offset:1024 nt
    s_waitcnt vmcnt(4)
    buffer_load_dwordx4 v[104:107], v2, s[36:39], s44 offen offset:2048 nt
    s_waitcnt vmcnt(4)
    buffer_load_dwordx4 v[108:111], v2, s[36:39], s44 offen offset:3072 nt
    s_waitcnt vmcnt(4)
    s_mov_b32 s44, 65536
    buffer_load_dwordx4 v[112:115], v2, s[36:39], s44 offen offset:0 nt
    s_waitcnt vmcnt(4)
    buffer_load_dwordx4 v[116:119], v2, s[36:39], s44 offen offset:1024 nt
    s_waitcnt vmcnt(4)
    buffer_load_dwordx4 v[120:123], v2, s[36:39], s44 offen offset:2048 nt
    s_waitcnt vmcnt(4)
    buffer_load_dwordx4 v[124:127], v2, s[36:39], s44 offen offset:3072 nt
    s_waitcnt vmcnt(4)
    s_mov_b32 s44, 81920
    buffer_load_dwordx4 v[128:131], v2, s[36:39], s44 offen offset:0 nt
    s_waitcnt vmcnt(4)
    buffer_load_dwordx4 v[132:135], v2, s[36:39], s44 offen offset:1024 nt
    s_waitcnt vmcnt(4)
    buffer_load_dwordx4 v[136:139], v2, s[36:39], s44 offen offset:2048 nt
    s_waitcnt vmcnt(4)
    buffer_load_dwordx4 v[140:143], v2, s[36:39], s44 offen offset:3072 nt
    s_waitcnt vmcnt(4)
    s_mov_b32 s44, 131072
    buffer_load_dwordx4 v[144:147], v2, s[36:39], s44 offen offset:0 nt
    s_waitcnt vmcnt(4)
    buffer_load_dwordx4 v[148:151], v2, s[36:39], s44 offen offset:1024 nt
    s_waitcnt vmcnt(4)
    buffer_load_dwordx4 v[152:155], v2, s[36:39], s44 offen offset:2048 nt
    s_waitcnt vmcnt(4)
    buffer_load_dwordx4 v[156:159], v2, s[36:39], s44 offen offset:3072 nt
    s_waitcnt vmcnt(4)
    s_mov_b32 s44, 147456
    buffer_load_dwordx4 v[160:163], v2, s[36:39], s44 offen offset:0 nt
    s_waitcnt vmcnt(4)
    buffer_load_dwordx4 v[164:167], v2, s[36:39], s44 offen offset:1024 nt
    s_waitcnt vmcnt(4)
    buffer_load_dwordx4 v[168:171], v2, s[36:39], s44 offen offset:2048 nt
    s_waitcnt vmcnt(4)
    buffer_load_dwordx4 v[172:175], v2, s[36:39], s44 offen offset:3072 nt
    s_waitcnt vmcnt(4)
    s_mov_b32 s44, 196608
    buffer_load_dwordx4 v[176:179], v2, s[36:39], s44 offen offset:0 nt
    s_waitcnt vmcnt(4)
    buffer_load_dwordx4 v[180:183], v2, s[36:39], s44 offen offset:1024 nt
    s_waitcnt vmcnt(4)
    buffer_load_dwordx4 v[184:187], v2, s[36:39], s44 offen offset:2048 nt
    s_waitcnt vmcnt(4)
    buffer_load_dwordx4 v[188:191], v2, s[36:39], s44 offen offset:3072 nt
    s_waitcnt vmcnt(4)
    s_mov_b32 s44, 212992
    buffer_load_dwordx4 v[192:195], v2, s[36:39], s44 offen offset:0 nt
    s_waitcnt vmcnt(4)
    buffer_load_dwordx4 v[196:199], v2, s[36:39], s44 offen offset:1024 nt
    s_waitcnt vmcnt(4)
    buffer_load_dwordx4 v[200:203], v2, s[36:39], s44 offen offset:2048 nt
    s_waitcnt vmcnt(4)
    buffer_load_dwordx4 v[204:207], v2, s[36:39], s44 offen offset:3072 nt
    s_waitcnt vmcnt(4)
    s_mov_b32 s44, 262144
    buffer_load_dwordx4 v[208:211], v2, s[36:39], s44 offen offset:0 nt
    s_waitcnt vmcnt(4)
    buffer_load_dwordx4 v[212:215], v2, s[36:39], s44 offen offset:1024 nt
    s_waitcnt vmcnt(4)
    buffer_load_dwordx4 v[216:219], v2, s[36:39], s44 offen offset:2048 nt
    s_waitcnt vmcnt(4)
    buffer_load_dwordx4 v[220:223], v2, s[36:39], s44 offen offset:3072 nt
    s_waitcnt vmcnt(4)
    s_mov_b32 s44, 278528
    buffer_load_dwordx4 v[224:227], v2, s[36:39], s44 offen offset:0 nt
    s_waitcnt vmcnt(4)
    buffer_load_dwordx4 v[228:231], v2, s[36:39], s44 offen offset:1024 nt
    s_waitcnt vmcnt(4)
    buffer_load_dwordx4 v[232:235], v2, s[36:39], s44 offen offset:2048 nt
    s_waitcnt vmcnt(4)
    buffer_load_dwordx4 v[236:239], v2, s[36:39], s44 offen offset:3072 nt
    s_waitcnt vmcnt(4)
    s_mov_b32 s44, 327680
    s_add_u32 m0, s49, 0
    s_nop 0
    buffer_load_dwordx4 v2, s[36:39], s44 offen offset:0 nt lds
    s_waitcnt vmcnt(4)
    buffer_load_dwordx4 v2, s[36:39], s44 offen offset:1024 nt lds
    s_waitcnt vmcnt(4)
    buffer_load_dwordx4 v2, s[36:39], s44 offen offset:2048 nt lds
    s_waitcnt vmcnt(4)
    buffer_load_dwordx4 v2, s[36:39], s44 offen offset:3072 nt lds
    s_waitcnt vmcnt(4)
    s_mov_b32 s44, 344064
    s_add_u32 m0, s49, 4096
    s_nop 0
    buffer_load_dwordx4 v2, s[36:39], s44 offen offset:0 nt lds
    s_waitcnt vmcnt(4)
    buffer_load_dwordx4 v2, s[36:39], s44 offen offset:1024 nt lds
    s_waitcnt vmcnt(4)
    buffer_load_dwordx4 v2, s[36:39], s44 offen offset:2048 nt lds
    s_waitcnt vmcnt(4)
    buffer_load_dwordx4 v2, s[36:39], s44 offen offset:3072 nt lds
    s_waitcnt vmcnt(4)
    s_mov_b32 s44, 393216
    s_add_u32 m0, s49, 8192
    s_nop 0
    buffer_load_dwordx4 v2, s[36:39], s44 offen offset:0 nt lds
    s_waitcnt vmcnt(4)
    buffer_load_dwordx4 v2, s[36:39], s44 offen offset:1024 nt lds
    s_waitcnt vmcnt(4)
    buffer_load_dwordx4 v2, s[36:39], s44 offen offset:2048 nt lds
    s_waitcnt vmcnt(4)
    buffer_load_dwordx4 v2, s[36:39], s44 offen offset:3072 nt lds
    s_waitcnt vmcnt(4)
    s_mov_b32 s44, 409600
    s_add_u32 m0, s49, 12288
    s_nop 0
    buffer_load_dwordx4 v2, s[36:39], s44 offen offset:0 nt lds
    s_waitcnt vmcnt(4)
    buffer_load_dwordx4 v2, s[36:39], s44 offen offset:1024 nt lds
    s_waitcnt vmcnt(4)
    buffer_load_dwordx4 v2, s[36:39], s44 offen offset:2048 nt lds
    s_waitcnt vmcnt(4)
    buffer_load_dwordx4 v2, s[36:39], s44 offen offset:3072 nt lds
    s_waitcnt vmcnt(4)
    s_mov_b32 s44, 458752
    s_add_u32 m0, s49, 16384
    s_nop 0
    buffer_load_dwordx4 v2, s[36:39], s44 offen offset:0 nt lds
    s_waitcnt vmcnt(4)
    buffer_load_dwordx4 v2, s[36:39], s44 offen offset:1024 nt lds
    s_waitcnt vmcnt(4)
    buffer_load_dwordx4 v2, s[36:39], s44 offen offset:2048 nt lds
    s_waitcnt vmcnt(4)
    buffer_load_dwordx4 v2, s[36:39], s44 offen offset:3072 nt lds
    s_waitcnt vmcnt(4)
    s_mov_b32 s44, 475136
    buffer_load_dwordx4 v[240:243], v2, s[36:39], s44 offen offset:0 nt
    s_waitcnt vmcnt(4)
    buffer_load_dwordx4 v[244:247], v2, s[36:39], s44 offen offset:1024 nt
    v_and_b32 v8, 3, v0
    v_lshlrev_b32 v8, 2, v8
    s_mov_b32 s62, 0x400000
    s_nop 0
L_qf:
    ds_read_b32 v9, v8 offset:4128
    s_waitcnt lgkmcnt(0)
    v_cmp_eq_u32 vcc, -1, v9
    s_nop 4
    s_cbranch_vccz L_qf_ok
    s_sleep 1
    s_sub_u32 s62, s62, 1
    s_cmp_gt_i32 s62, 0
    s_cbranch_scc1 L_qf
L_qf_ok:
    ds_read_b128 v[48:51], v4 offset:0
    ds_read_b128 v[52:55], v4 offset:16
    ds_read_b128 v[56:59], v4 offset:512
    ds_read_b128 v[60:63], v4 offset:528
    ds_read_b128 v[64:67], v4 offset:1024
    ds_read_b128 v[68:71], v4 offset:1040
    ds_read_b128 v[72:75], v4 offset:1536
    ds_read_b128 v[76:79], v4 offset:1552
    s_waitcnt vmcnt(4)
    buffer_load_dwordx4 v[248:251], v2, s[36:39], s44 offen offset:2048 nt
    s_waitcnt lgkmcnt(0)
    v_add_f32 v48, v48, v56
    v_add_f32 v49, v49, v57
    v_add_f32 v50, v50, v58
    v_add_f32 v51, v51, v59
    v_add_f32 v52, v52, v60
    v_add_f32 v53, v53, v61
    v_add_f32 v54, v54, v62
    v_add_f32 v55, v55, v63
    v_add_f32 v64, v64, v72
    v_add_f32 v65, v65, v73
    v_add_f32 v66, v66, v74
    v_add_f32 v67, v67, v75
    v_add_f32 v68, v68, v76
    v_add_f32 v69, v69, v77
    v_add_f32 v70, v70, v78
    v_add_f32 v71, v71, v79
    v_add_f32 v48, v48, v64
    v_add_f32 v49, v49, v65
    v_add_f32 v50, v50, v66
    v_add_f32 v51, v51, v67
    v_add_f32 v52, v52, v68
    v_add_f32 v53, v53, v69
    v_add_f32 v54, v54, v70
    v_add_f32 v55, v55, v71
    v_cvt_pk_bf16_f32 v56, v48, v49
    v_cvt_pk_bf16_f32 v57, v50, v51
    v_cvt_pk_bf16_f32 v58, v52, v53
    v_cvt_pk_bf16_f32 v59, v54, v55
    s_waitcnt vmcnt(4)
    buffer_load_dwordx4 v[252:255], v2, s[36:39], s44 offen offset:3072 nt
    v_mov_b32_dpp v32, v56 quad_perm:[0,1,2,3] row_mask:0xf bank_mask:0x1
    v_mov_b32_dpp v33, v57 quad_perm:[0,1,2,3] row_mask:0xf bank_mask:0x1
    v_mov_b32_dpp v34, v58 quad_perm:[0,1,2,3] row_mask:0xf bank_mask:0x1
    v_mov_b32_dpp v35, v59 quad_perm:[0,1,2,3] row_mask:0xf bank_mask:0x1
    v_mov_b32_dpp v36, v56 quad_perm:[0,1,2,3] row_mask:0xf bank_mask:0x2
    v_mov_b32_dpp v37, v57 quad_perm:[0,1,2,3] row_mask:0xf bank_mask:0x2
    v_mov_b32_dpp v38, v58 quad_perm:[0,1,2,3] row_mask:0xf bank_mask:0x2
    v_mov_b32_dpp v39, v59 quad_perm:[0,1,2,3] row_mask:0xf bank_mask:0x2
    v_mov_b32_dpp v40, v56 quad_perm:[0,1,2,3] row_mask:0xf bank_mask:0x4
    v_mov_b32_dpp v41, v57 quad_perm:[0,1,2,3] row_mask:0xf bank_mask:0x4
    v_mov_b32_dpp v42, v58 quad_perm:[0,1,2,3] row_mask:0xf bank_mask:0x4
    v_mov_b32_dpp v43, v59 quad_perm:[0,1,2,3] row_mask:0xf bank_mask:0x4
    v_mov_b32_dpp v44, v56 quad_perm:[0,1,2,3] row_mask:0xf bank_mask:0x8
    v_mov_b32_dpp v45, v57 quad_perm:[0,1,2,3] row_mask:0xf bank_mask:0x8
    v_mov_b32_dpp v46, v58 quad_perm:[0,1,2,3] row_mask:0xf bank_mask:0x8
    v_mov_b32_dpp v47, v59 quad_perm:[0,1,2,3] row_mask:0xf bank_mask:0x8
    v_mfma_f32_16x16x32_bf16 v[24:27], v[80:83], v[32:35], 0
    v_mfma_f32_16x16x32_bf16 v[24:27], v[84:87], v[36:39], v[24:27]
    v_mfma_f32_16x16x32_bf16 v[24:27], v[88:91], v[40:43], v[24:27]
    v_mfma_f32_16x16x32_bf16 v[24:27], v[92:95], v[44:47], v[24:27]
    s_waitcnt vmcnt(4)
    s_mov_b32 s44, 524288
    buffer_load_dwordx4 v[80:83], v2, s[36:39], s44 offen offset:0 nt
    s_add_u32 s74, s74, 1
    s_lshl_b32 s69, s28, 12
    s_add_u32 s69, s69, 1183744
    s_add_u32 s56, s26, s69
    s_addc_u32 s57, s27, 0
    s_and_b32 s57, s57, 0xffff
    s_mov_b32 s58, 4096
    s_mov_b32 s59, 0x20000
    s_mov_b32 s64, s56
    s_mov_b32 s65, s57
    s_mov_b32 s67, 0x20000
    s_cmp_eq_u32 s3, 1
    s_cselect_b32 s66, 4096, 0
    s_lshl_b32 s70, s29, 2
    s_mov_b32 s68, 0
    v_mov_b32 v14, s74
    v_and_b32 v13, 31, v0
    v_lshlrev_b32 v13, 2, v13
    s_mov_b32 s52, s24
    s_and_b32 s53, s25, 0xffff
    s_mov_b32 s54, 0
    s_mov_b32 s55, 0x20000
    s_lshl2_add_u32 s69, s29, s3
    s_cmp_eq_u32 s69, 81
    s_cselect_b32 s54, 256, 0
    s_lshl_b32 s71, s28, 2
    v_mov_b32 v15, 1
    s_waitcnt vmcnt(4)
    buffer_load_dwordx4 v[84:87], v2, s[36:39], s44 offen offset:1024 nt
    v_mfma_f32_16x16x32_bf16 v[28:31], v[96:99], v[32:35], 0
    v_mov_b32_dpp v8, v24 quad_perm:[0,0,0,0] row_mask:0xf bank_mask:0xf
    v_mov_b32_dpp v9, v26 quad_perm:[2,2,2,2] row_mask:0xf bank_mask:0xf
    v_mfma_f32_16x16x32_bf16 v[28:31], v[100:103], v[36:39], v[28:31]
    v_add_f32_dpp v8, v25, v8 quad_perm:[1,1,1,1] row_mask:0xf bank_mask:0xf
    v_add_f32_dpp v9, v27, v9 quad_perm:[3,3,3,3] row_mask:0xf bank_mask:0xf
    v_add_f32 v8, v8, v9
    v_mfma_f32_16x16x32_bf16 v[28:31], v[104:107], v[40:43], v[28:31]
    v_cvt_pk_bf16_f32 v8, 0, v8
    v_mul_f32 v8, s47, v8
    v_mfma_f32_16x16x32_bf16 v[28:31], v[108:111], v[44:47], v[28:31]
    v_cvt_pk_bf16_f32 v48, 0, v8
    v_max_f32 v10, v10, v48
    s_waitcnt vmcnt(4)
    buffer_load_dwordx4 v[88:91], v2, s[36:39], s44 offen offset:2048 nt
    s_waitcnt vmcnt(4)
    buffer_load_dwordx4 v[92:95], v2, s[36:39], s44 offen offset:3072 nt
    v_mfma_f32_16x16x32_bf16 v[24:27], v[112:115], v[32:35], 0
    s_nop 0
    v_mov_b32_dpp v8, v28 quad_perm:[0,0,0,0] row_mask:0xf bank_mask:0xf
    v_mov_b32_dpp v9, v30 quad_perm:[2,2,2,2] row_mask:0xf bank_mask:0xf
    v_mfma_f32_16x16x32_bf16 v[24:27], v[116:119], v[36:39], v[24:27]
    v_add_f32_dpp v8, v29, v8 quad_perm:[1,1,1,1] row_mask:0xf bank_mask:0xf
    v_add_f32_dpp v9, v31, v9 quad_perm:[3,3,3,3] row_mask:0xf bank_mask:0xf
    v_add_f32 v8, v8, v9
    v_mfma_f32_16x16x32_bf16 v[24:27], v[120:123], v[40:43], v[24:27]
    v_cvt_pk_bf16_f32 v8, 0, v8
    v_mul_f32 v8, s47, v8
    v_mfma_f32_16x16x32_bf16 v[24:27], v[124:127], v[44:47], v[24:27]
    v_cvt_pk_bf16_f32 v49, 0, v8
    v_max_f32 v10, v10, v49
    s_waitcnt vmcnt(4)
    s_mov_b32 s44, 540672
    buffer_load_dwordx4 v[96:99], v2, s[36:39], s44 offen offset:0 nt
    s_waitcnt vmcnt(4)
    buffer_load_dwordx4 v[100:103], v2, s[36:39], s44 offen offset:1024 nt
    v_mfma_f32_16x16x32_bf16 v[28:31], v[128:131], v[32:35], 0
    v_mov_b32_dpp v8, v24 quad_perm:[0,0,0,0] row_mask:0xf bank_mask:0xf
    v_mov_b32_dpp v9, v26 quad_perm:[2,2,2,2] row_mask:0xf bank_mask:0xf
    v_mfma_f32_16x16x32_bf16 v[28:31], v[132:135], v[36:39], v[28:31]
    v_add_f32_dpp v8, v25, v8 quad_perm:[1,1,1,1] row_mask:0xf bank_mask:0xf
    v_add_f32_dpp v9, v27, v9 quad_perm:[3,3,3,3] row_mask:0xf bank_mask:0xf
    v_add_f32 v8, v8, v9
    v_mfma_f32_16x16x32_bf16 v[28:31], v[136:139], v[40:43], v[28:31]
    v_cvt_pk_bf16_f32 v8, 0, v8
    v_mul_f32 v8, s47, v8
    v_mfma_f32_16x16x32_bf16 v[28:31], v[140:143], v[44:47], v[28:31]
    v_cvt_pk_bf16_f32 v50, 0, v8
    v_max_f32 v10, v10, v50
    s_waitcnt vmcnt(4)
    buffer_load_dwordx4 v[104:107], v2, s[36:39], s44 offen offset:2048 nt
    s_waitcnt vmcnt(4)
    buffer_load_dwordx4 v[108:111], v2, s[36:39], s44 offen offset:3072 nt
    v_mfma_f32_16x16x32_bf16 v[24:27], v[144:147], v[32:35], 0
    s_nop 0
    v_mov_b32_dpp v8, v28 quad_perm:[0,0,0,0] row_mask:0xf bank_mask:0xf
    v_mov_b32_dpp v9, v30 quad_perm:[2,2,2,2] row_mask:0xf bank_mask:0xf
    v_mfma_f32_16x16x32_bf16 v[24:27], v[148:151], v[36:39], v[24:27]
    v_add_f32_dpp v8, v29, v8 quad_perm:[1,1,1,1] row_mask:0xf bank_mask:0xf
    v_add_f32_dpp v9, v31, v9 quad_perm:[3,3,3,3] row_mask:0xf bank_mask:0xf
    v_add_f32 v8, v8, v9
    v_mfma_f32_16x16x32_bf16 v[24:27], v[152:155], v[40:43], v[24:27]
    v_cvt_pk_bf16_f32 v8, 0, v8
    v_mul_f32 v8, s47, v8
    v_mfma_f32_16x16x32_bf16 v[24:27], v[156:159], v[44:47], v[24:27]
    v_cvt_pk_bf16_f32 v51, 0, v8
    v_max_f32 v10, v10, v51
    ds_read_b128 v[128:131], v7 offset:0
    ds_read_b128 v[132:135], v7 offset:1024
    ds_read_b128 v[136:139], v7 offset:2048
    ds_read_b128 v[140:143], v7 offset:3072
    s_waitcnt vmcnt(4)
    s_mov_b32 s44, 589824
    buffer_load_dwordx4 v[112:115], v2, s[36:39], s44 offen offset:0 nt
    s_waitcnt lgkmcnt(0)
    v_mfma_f32_16x16x32_bf16 v[28:31], v[128:131], v[32:35], 0
    v_mov_b32_dpp v8, v24 quad_perm:[0,0,0,0] row_mask:0xf bank_mask:0xf
    v_mov_b32_dpp v9, v26 quad_perm:[2,2,2,2] row_mask:0xf bank_mask:0xf
    v_mfma_f32_16x16x32_bf16 v[28:31], v[132:135], v[36:39], v[28:31]
    v_add_f32_dpp v8, v25, v8 quad_perm:[1,1,1,1] row_mask:0xf bank_mask:0xf
    v_add_f32_dpp v9, v27, v9 quad_perm:[3,3,3,3] row_mask:0xf bank_mask:0xf
    v_add_f32 v8, v8, v9
    v_mfma_f32_16x16x32_bf16 v[28:31], v[136:139], v[40:43], v[28:31]
    v_cvt_pk_bf16_f32 v8, 0, v8
    v_mul_f32 v8, s47, v8
    v_mfma_f32_16x16x32_bf16 v[28:31], v[140:143], v[44:47], v[28:31]
    v_cvt_pk_bf16_f32 v52, 0, v8
    v_max_f32 v10, v10, v52
    s_waitcnt vmcnt(4)
    buffer_load_dwordx4 v[116:119], v2, s[36:39], s44 offen offset:1024 nt
    v_mfma_f32_16x16x32_bf16 v[24:27], v[160:163], v[32:35], 0
    s_nop 2
    v_mov_b32_dpp v8, v28 quad_perm:[0,0,0,0] row_mask:0xf bank_mask:0xf
    v_mov_b32_dpp v9, v30 quad_perm:[2,2,2,2] row_mask:0xf bank_mask:0xf
    v_mfma_f32_16x16x32_bf16 v[24:27], v[164:167], v[36:39], v[24:27]
    v_add_f32_dpp v8, v29, v8 quad_perm:[1,1,1,1] row_mask:0xf bank_mask:0xf
    v_add_f32_dpp v9, v31, v9 quad_perm:[3,3,3,3] row_mask:0xf bank_mask:0xf
    v_add_f32 v8, v8, v9
    v_mfma_f32_16x16x32_bf16 v[24:27], v[168:171], v[40:43], v[24:27]
    v_cvt_pk_bf16_f32 v8, 0, v8
    v_mul_f32 v8, s47, v8
    v_mfma_f32_16x16x32_bf16 v[24:27], v[172:175], v[44:47], v[24:27]
    v_cvt_pk_bf16_f32 v58, 0, v8
    v_max_f32 v10, v10, v58
    ds_read_b128 v[136:139], v7 offset:4096
    ds_read_b128 v[140:143], v7 offset:5120
    ds_read_b128 v[144:147], v7 offset:6144
    ds_read_b128 v[148:151], v7 offset:7168
    s_waitcnt vmcnt(4)
    buffer_load_dwordx4 v[120:123], v2, s[36:39], s44 offen offset:2048 nt
    s_waitcnt lgkmcnt(0)
    v_mfma_f32_16x16x32_bf16 v[28:31], v[136:139], v[32:35], 0
    v_mov_b32_dpp v8, v24 quad_perm:[0,0,0,0] row_mask:0xf bank_mask:0xf
    v_mov_b32_dpp v9, v26 quad_perm:[2,2,2,2] row_mask:0xf bank_mask:0xf
    v_mfma_f32_16x16x32_bf16 v[28:31], v[140:143], v[36:39], v[28:31]
    v_add_f32_dpp v8, v25, v8 quad_perm:[1,1,1,1] row_mask:0xf bank_mask:0xf
    v_add_f32_dpp v9, v27, v9 quad_perm:[3,3,3,3] row_mask:0xf bank_mask:0xf
    v_add_f32 v8, v8, v9
    v_mfma_f32_16x16x32_bf16 v[28:31], v[144:147], v[40:43], v[28:31]
    v_cvt_pk_bf16_f32 v8, 0, v8
    v_mul_f32 v8, s47, v8
    v_mfma_f32_16x16x32_bf16 v[28:31], v[148:151], v[44:47], v[28:31]
    v_cvt_pk_bf16_f32 v53, 0, v8
    v_max_f32 v10, v10, v53
    s_waitcnt vmcnt(4)
    buffer_load_dwordx4 v[124:127], v2, s[36:39], s44 offen offset:3072 nt
    v_mfma_f32_16x16x32_bf16 v[24:27], v[176:179], v[32:35], 0
    s_nop 2
    v_mov_b32_dpp v8, v28 quad_perm:[0,0,0,0] row_mask:0xf bank_mask:0xf
    v_mov_b32_dpp v9, v30 quad_perm:[2,2,2,2] row_mask:0xf bank_mask:0xf
    v_mfma_f32_16x16x32_bf16 v[24:27], v[180:183], v[36:39], v[24:27]
    v_add_f32_dpp v8, v29, v8 quad_perm:[1,1,1,1] row_mask:0xf bank_mask:0xf
    v_add_f32_dpp v9, v31, v9 quad_perm:[3,3,3,3] row_mask:0xf bank_mask:0xf
    v_add_f32 v8, v8, v9
    v_mfma_f32_16x16x32_bf16 v[24:27], v[184:187], v[40:43], v[24:27]
    v_cvt_pk_bf16_f32 v8, 0, v8
    v_mul_f32 v8, s47, v8
    v_mfma_f32_16x16x32_bf16 v[24:27], v[188:191], v[44:47], v[24:27]
    v_cvt_pk_bf16_f32 v59, 0, v8
    v_max_f32 v10, v10, v59
    ds_read_b128 v[144:147], v7 offset:8192
    ds_read_b128 v[148:151], v7 offset:9216
    ds_read_b128 v[152:155], v7 offset:10240
    ds_read_b128 v[156:159], v7 offset:11264
    s_waitcnt vmcnt(4)
    s_mov_b32 s44, 606208
    buffer_load_dwordx4 v[128:131], v2, s[36:39], s44 offen offset:0 nt
    s_waitcnt lgkmcnt(0)
    v_mfma_f32_16x16x32_bf16 v[28:31], v[144:147], v[32:35], 0
    v_mov_b32_dpp v8, v24 quad_perm:[0,0,0,0] row_mask:0xf bank_mask:0xf
    v_mov_b32_dpp v9, v26 quad_perm:[2,2,2,2] row_mask:0xf bank_mask:0xf
    v_mfma_f32_16x16x32_bf16 v[28:31], v[148:151], v[36:39], v[28:31]
    v_add_f32_dpp v8, v25, v8 quad_perm:[1,1,1,1] row_mask:0xf bank_mask:0xf
    v_add_f32_dpp v9, v27, v9 quad_perm:[3,3,3,3] row_mask:0xf bank_mask:0xf
    v_add_f32 v8, v8, v9
    v_mfma_f32_16x16x32_bf16 v[28:31], v[152:155], v[40:43], v[28:31]
    v_cvt_pk_bf16_f32 v8, 0, v8
    v_mul_f32 v8, s47, v8
    v_mfma_f32_16x16x32_bf16 v[28:31], v[156:159], v[44:47], v[28:31]
    v_cvt_pk_bf16_f32 v54, 0, v8
    v_max_f32 v10, v10, v54
    s_waitcnt vmcnt(4)
    buffer_load_dwordx4 v[132:135], v2, s[36:39], s44 offen offset:1024 nt
    v_mfma_f32_16x16x32_bf16 v[24:27], v[192:195], v[32:35], 0
    s_nop 2
    v_mov_b32_dpp v8, v28 quad_perm:[0,0,0,0] row_mask:0xf bank_mask:0xf
    v_mov_b32_dpp v9, v30 quad_perm:[2,2,2,2] row_mask:0xf bank_mask:0xf
    v_mfma_f32_16x16x32_bf16 v[24:27], v[196:199], v[36:39], v[24:27]
    v_add_f32_dpp v8, v29, v8 quad_perm:[1,1,1,1] row_mask:0xf bank_mask:0xf
    v_add_f32_dpp v9, v31, v9 quad_perm:[3,3,3,3] row_mask:0xf bank_mask:0xf
    v_add_f32 v8, v8, v9
    v_mfma_f32_16x16x32_bf16 v[24:27], v[200:203], v[40:43], v[24:27]
    v_cvt_pk_bf16_f32 v8, 0, v8
    v_mul_f32 v8, s47, v8
    v_mfma_f32_16x16x32_bf16 v[24:27], v[204:207], v[44:47], v[24:27]
    v_cvt_pk_bf16_f32 v60, 0, v8
    v_max_f32 v10, v10, v60
    ds_read_b128 v[152:155], v7 offset:12288
    ds_read_b128 v[156:159], v7 offset:13312
    ds_read_b128 v[160:163], v7 offset:14336
    ds_read_b128 v[164:167], v7 offset:15360
    s_waitcnt vmcnt(4)
    buffer_load_dwordx4 v[136:139], v2, s[36:39], s44 offen offset:2048 nt
    s_waitcnt lgkmcnt(0)
    v_mfma_f32_16x16x32_bf16 v[28:31], v[152:155], v[32:35], 0
    v_mov_b32_dpp v8, v24 quad_perm:[0,0,0,0] row_mask:0xf bank_mask:0xf
    v_mov_b32_dpp v9, v26 quad_perm:[2,2,2,2] row_mask:0xf bank_mask:0xf
    v_mfma_f32_16x16x32_bf16 v[28:31], v[156:159], v[36:39], v[28:31]
    v_add_f32_dpp v8, v25, v8 quad_perm:[1,1,1,1] row_mask:0xf bank_mask:0xf
    v_add_f32_dpp v9, v27, v9 quad_perm:[3,3,3,3] row_mask:0xf bank_mask:0xf
    v_add_f32 v8, v8, v9
    v_mfma_f32_16x16x32_bf16 v[28:31], v[160:163], v[40:43], v[28:31]
    v_cvt_pk_bf16_f32 v8, 0, v8
    v_mul_f32 v8, s47, v8
    v_mfma_f32_16x16x32_bf16 v[28:31], v[164:167], v[44:47], v[28:31]
    v_cvt_pk_bf16_f32 v55, 0, v8
    v_max_f32 v10, v10, v55
    s_waitcnt vmcnt(4)
    buffer_load_dwordx4 v[140:143], v2, s[36:39], s44 offen offset:3072 nt
    v_mfma_f32_16x16x32_bf16 v[24:27], v[208:211], v[32:35], 0
    s_nop 2
    v_mov_b32_dpp v8, v28 quad_perm:[0,0,0,0] row_mask:0xf bank_mask:0xf
    v_mov_b32_dpp v9, v30 quad_perm:[2,2,2,2] row_mask:0xf bank_mask:0xf
    v_mfma_f32_16x16x32_bf16 v[24:27], v[212:215], v[36:39], v[24:27]
    v_add_f32_dpp v8, v29, v8 quad_perm:[1,1,1,1] row_mask:0xf bank_mask:0xf
    v_add_f32_dpp v9, v31, v9 quad_perm:[3,3,3,3] row_mask:0xf bank_mask:0xf
    v_add_f32 v8, v8, v9
    v_mfma_f32_16x16x32_bf16 v[24:27], v[216:219], v[40:43], v[24:27]
    v_cvt_pk_bf16_f32 v8, 0, v8
    v_mul_f32 v8, s47, v8
    v_mfma_f32_16x16x32_bf16 v[24:27], v[220:223], v[44:47], v[24:27]
    v_cvt_pk_bf16_f32 v61, 0, v8
    v_max_f32 v10, v10, v61
    ds_read_b128 v[160:163], v7 offset:16384
    ds_read_b128 v[164:167], v7 offset:17408
    ds_read_b128 v[168:171], v7 offset:18432
    ds_read_b128 v[172:175], v7 offset:19456
    s_waitcnt vmcnt(4)
    s_mov_b32 s44, 655360
    buffer_load_dwordx4 v[144:147], v2, s[36:39], s44 offen offset:0 nt
    s_waitcnt lgkmcnt(0)
    v_mfma_f32_16x16x32_bf16 v[28:31], v[160:163], v[32:35], 0
    v_mov_b32_dpp v8, v24 quad_perm:[0,0,0,0] row_mask:0xf bank_mask:0xf
    v_mov_b32_dpp v9, v26 quad_perm:[2,2,2,2] row_mask:0xf bank_mask:0xf
    v_mfma_f32_16x16x32_bf16 v[28:31], v[164:167], v[36:39], v[28:31]
    v_add_f32_dpp v8, v25, v8 quad_perm:[1,1,1,1] row_mask:0xf bank_mask:0xf
    v_add_f32_dpp v9, v27, v9 quad_perm:[3,3,3,3] row_mask:0xf bank_mask:0xf
    v_add_f32 v8, v8, v9
    v_mfma_f32_16x16x32_bf16 v[28:31], v[168:171], v[40:43], v[28:31]
    v_cvt_pk_bf16_f32 v8, 0, v8
    v_mul_f32 v8, s47, v8
    v_mfma_f32_16x16x32_bf16 v[28:31], v[172:175], v[44:47], v[28:31]
    v_cvt_pk_bf16_f32 v56, 0, v8
    v_max_f32 v10, v10, v56
    s_waitcnt vmcnt(4)
    buffer_load_dwordx4 v[148:151], v2, s[36:39], s44 offen offset:1024 nt
    v_mfma_f32_16x16x32_bf16 v[24:27], v[224:227], v[32:35], 0
    s_nop 2
    v_mov_b32_dpp v8, v28 quad_perm:[0,0,0,0] row_mask:0xf bank_mask:0xf
    v_mov_b32_dpp v9, v30 quad_perm:[2,2,2,2] row_mask:0xf bank_mask:0xf
    v_mfma_f32_16x16x32_bf16 v[24:27], v[228:231], v[36:39], v[24:27]
    v_add_f32_dpp v8, v29, v8 quad_perm:[1,1,1,1] row_mask:0xf bank_mask:0xf
    v_add_f32_dpp v9, v31, v9 quad_perm:[3,3,3,3] row_mask:0xf bank_mask:0xf
    v_add_f32 v8, v8, v9
    v_mfma_f32_16x16x32_bf16 v[24:27], v[232:235], v[40:43], v[24:27]
    v_cvt_pk_bf16_f32 v8, 0, v8
    v_mul_f32 v8, s47, v8
    v_mfma_f32_16x16x32_bf16 v[24:27], v[236:239], v[44:47], v[24:27]
    v_cvt_pk_bf16_f32 v62, 0, v8
    v_max_f32 v10, v10, v62
    s_waitcnt vmcnt(4)
    buffer_load_dwordx4 v[152:155], v2, s[36:39], s44 offen offset:2048 nt
    s_waitcnt vmcnt(4)
    buffer_load_dwordx4 v[156:159], v2, s[36:39], s44 offen offset:3072 nt
    v_mfma_f32_16x16x32_bf16 v[28:31], v[240:243], v[32:35], 0
    s_nop 0
    v_mov_b32_dpp v8, v24 quad_perm:[0,0,0,0] row_mask:0xf bank_mask:0xf
    v_mov_b32_dpp v9, v26 quad_perm:[2,2,2,2] row_mask:0xf bank_mask:0xf
    v_mfma_f32_16x16x32_bf16 v[28:31], v[244:247], v[36:39], v[28:31]
    v_add_f32_dpp v8, v25, v8 quad_perm:[1,1,1,1] row_mask:0xf bank_mask:0xf
    v_add_f32_dpp v9, v27, v9 quad_perm:[3,3,3,3] row_mask:0xf bank_mask:0xf
    v_add_f32 v8, v8, v9
    v_mfma_f32_16x16x32_bf16 v[28:31], v[248:251], v[40:43], v[28:31]
    v_cvt_pk_bf16_f32 v8, 0, v8
    v_mul_f32 v8, s47, v8
    v_mfma_f32_16x16x32_bf16 v[28:31], v[252:255], v[44:47], v[28:31]
    v_cvt_pk_bf16_f32 v57, 0, v8
    v_max_f32 v10, v10, v57
    s_waitcnt vmcnt(4)
    s_mov_b32 s44, 671744
    buffer_load_dwordx4 v[160:163], v2, s[36:39], s44 offen offset:0 nt
    s_waitcnt vmcnt(4)
    buffer_load_dwordx4 v[164:167], v2, s[36:39], s44 offen offset:1024 nt
    v_mfma_f32_16x16x32_bf16 v[24:27], v[80:83], v[32:35], 0
    v_mov_b32_dpp v8, v28 quad_perm:[0,0,0,0] row_mask:0xf bank_mask:0xf
    v_mov_b32_dpp v9, v30 quad_perm:[2,2,2,2] row_mask:0xf bank_mask:0xf
    v_mfma_f32_16x16x32_bf16 v[24:27], v[84:87], v[36:39], v[24:27]
    v_add_f32_dpp v8, v29, v8 quad_perm:[1,1,1,1] row_mask:0xf bank_mask:0xf
    v_add_f32_dpp v9, v31, v9 quad_perm:[3,3,3,3] row_mask:0xf bank_mask:0xf
    v_add_f32 v8, v8, v9
    v_mfma_f32_16x16x32_bf16 v[24:27], v[88:91], v[40:43], v[24:27]
    v_cvt_pk_bf16_f32 v8, 0, v8
    v_mul_f32 v8, s47, v8
    v_mfma_f32_16x16x32_bf16 v[24:27], v[92:95], v[44:47], v[24:27]
    v_cvt_pk_bf16_f32 v63, 0, v8
    v_max_f32 v10, v10, v63
    s_waitcnt vmcnt(4)
    buffer_load_dwordx4 v[168:171], v2, s[36:39], s44 offen offset:2048 nt
    s_waitcnt vmcnt(4)
    buffer_load_dwordx4 v[172:175], v2, s[36:39], s44 offen offset:3072 nt
    v_mfma_f32_16x16x32_bf16 v[28:31], v[96:99], v[32:35], 0
    s_nop 0
    v_mov_b32_dpp v8, v24 quad_perm:[0,0,0,0] row_mask:0xf bank_mask:0xf
    v_mov_b32_dpp v9, v26 quad_perm:[2,2,2,2] row_mask:0xf bank_mask:0xf
    v_mfma_f32_16x16x32_bf16 v[28:31], v[100:103], v[36:39], v[28:31]
    v_add_f32_dpp v8, v25, v8 quad_perm:[1,1,1,1] row_mask:0xf bank_mask:0xf
    v_add_f32_dpp v9, v27, v9 quad_perm:[3,3,3,3] row_mask:0xf bank_mask:0xf
    v_add_f32 v8, v8, v9
    v_mfma_f32_16x16x32_bf16 v[28:31], v[104:107], v[40:43], v[28:31]
    v_cvt_pk_bf16_f32 v8, 0, v8
    v_mul_f32 v8, s47, v8
    v_mfma_f32_16x16x32_bf16 v[28:31], v[108:111], v[44:47], v[28:31]
    v_cvt_pk_bf16_f32 v64, 0, v8
    v_max_f32 v10, v10, v64
    s_waitcnt vmcnt(4)
    s_mov_b32 s44, 720896
    buffer_load_dwordx4 v[176:179], v2, s[36:39], s44 offen offset:0 nt
    s_waitcnt vmcnt(4)
    buffer_load_dwordx4 v[180:183], v2, s[36:39], s44 offen offset:1024 nt
    v_mfma_f32_16x16x32_bf16 v[24:27], v[112:115], v[32:35], 0
    v_mov_b32_dpp v8, v28 quad_perm:[0,0,0,0] row_mask:0xf bank_mask:0xf
    v_mov_b32_dpp v9, v30 quad_perm:[2,2,2,2] row_mask:0xf bank_mask:0xf
    v_mfma_f32_16x16x32_bf16 v[24:27], v[116:119], v[36:39], v[24:27]
    v_add_f32_dpp v8, v29, v8 quad_perm:[1,1,1,1] row_mask:0xf bank_mask:0xf
    v_add_f32_dpp v9, v31, v9 quad_perm:[3,3,3,3] row_mask:0xf bank_mask:0xf
    v_add_f32 v8, v8, v9
    v_mfma_f32_16x16x32_bf16 v[24:27], v[120:123], v[40:43], v[24:27]
    v_cvt_pk_bf16_f32 v8, 0, v8
    v_mul_f32 v8, s47, v8
    v_mfma_f32_16x16x32_bf16 v[24:27], v[124:127], v[44:47], v[24:27]
    v_cvt_pk_bf16_f32 v65, 0, v8
    v_max_f32 v10, v10, v65
    s_waitcnt vmcnt(4)
    buffer_load_dwordx4 v[184:187], v2, s[36:39], s44 offen offset:2048 nt
    s_waitcnt vmcnt(4)
    buffer_load_dwordx4 v[188:191], v2, s[36:39], s44 offen offset:3072 nt
    v_mfma_f32_16x16x32_bf16 v[28:31], v[128:131], v[32:35], 0
    s_nop 0
    v_mov_b32_dpp v8, v24 quad_perm:[0,0,0,0] row_mask:0xf bank_mask:0xf
    v_mov_b32_dpp v9, v26 quad_perm:[2,2,2,2] row_mask:0xf bank_mask:0xf
    v_mfma_f32_16x16x32_bf16 v[28:31], v[132:135], v[36:39], v[28:31]
    v_add_f32_dpp v8, v25, v8 quad_perm:[1,1,1,1] row_mask:0xf bank_mask:0xf
    v_add_f32_dpp v9, v27, v9 quad_perm:[3,3,3,3] row_mask:0xf bank_mask:0xf
    v_add_f32 v8, v8, v9
    v_mfma_f32_16x16x32_bf16 v[28:31], v[136:139], v[40:43], v[28:31]
    v_cvt_pk_bf16_f32 v8, 0, v8
    v_mul_f32 v8, s47, v8
    v_mfma_f32_16x16x32_bf16 v[28:31], v[140:143], v[44:47], v[28:31]
    v_cvt_pk_bf16_f32 v66, 0, v8
    v_max_f32 v10, v10, v66
    s_waitcnt vmcnt(4)
    s_mov_b32 s44, 737280
    buffer_load_dwordx4 v[192:195], v2, s[36:39], s44 offen offset:0 nt
    s_waitcnt vmcnt(4)
    buffer_load_dwordx4 v[196:199], v2, s[36:39], s44 offen offset:1024 nt
    v_mfma_f32_16x16x32_bf16 v[24:27], v[144:147], v[32:35], 0
    v_mov_b32_dpp v8, v28 quad_perm:[0,0,0,0] row_mask:0xf bank_mask:0xf
    v_mov_b32_dpp v9, v30 quad_perm:[2,2,2,2] row_mask:0xf bank_mask:0xf
    v_mfma_f32_16x16x32_bf16 v[24:27], v[148:151], v[36:39], v[24:27]
    v_add_f32_dpp v8, v29, v8 quad_perm:[1,1,1,1] row_mask:0xf bank_mask:0xf
    v_add_f32_dpp v9, v31, v9 quad_perm:[3,3,3,3] row_mask:0xf bank_mask:0xf
    v_add_f32 v8, v8, v9
    v_mfma_f32_16x16x32_bf16 v[24:27], v[152:155], v[40:43], v[24:27]
    v_cvt_pk_bf16_f32 v8, 0, v8
    v_mul_f32 v8, s47, v8
    v_mfma_f32_16x16x32_bf16 v[24:27], v[156:159], v[44:47], v[24:27]
    v_cvt_pk_bf16_f32 v67, 0, v8
    v_max_f32 v10, v10, v67
    s_waitcnt vmcnt(4)
    buffer_load_dwordx4 v[200:203], v2, s[36:39], s44 offen offset:2048 nt
    s_waitcnt vmcnt(4)
    buffer_load_dwordx4 v[204:207], v2, s[36:39], s44 offen offset:3072 nt
    v_mfma_f32_16x16x32_bf16 v[28:31], v[160:163], v[32:35], 0
    s_nop 0
    v_mov_b32_dpp v8, v24 quad_perm:[0,0,0,0] row_mask:0xf bank_mask:0xf
    v_mov_b32_dpp v9, v26 quad_perm:[2,2,2,2] row_mask:0xf bank_mask:0xf
    v_mfma_f32_16x16x32_bf16 v[28:31], v[164:167], v[36:39], v[28:31]
    v_add_f32_dpp v8, v25, v8 quad_perm:[1,1,1,1] row_mask:0xf bank_mask:0xf
    v_add_f32_dpp v9, v27, v9 quad_perm:[3,3,3,3] row_mask:0xf bank_mask:0xf
    v_add_f32 v8, v8, v9
    v_mfma_f32_16x16x32_bf16 v[28:31], v[168:171], v[40:43], v[28:31]
    v_cvt_pk_bf16_f32 v8, 0, v8
    v_mul_f32 v8, s47, v8
    v_mfma_f32_16x16x32_bf16 v[28:31], v[172:175], v[44:47], v[28:31]
    v_cvt_pk_bf16_f32 v68, 0, v8
    v_max_f32 v10, v10, v68
    s_waitcnt vmcnt(4)
    s_mov_b32 s44, 786432
    buffer_load_dwordx4 v[208:211], v2, s[36:39], s44 offen offset:0 nt
    s_waitcnt vmcnt(4)
    buffer_load_dwordx4 v[212:215], v2, s[36:39], s44 offen offset:1024 nt
    v_mfma_f32_16x16x32_bf16 v[24:27], v[176:179], v[32:35], 0
    v_mov_b32_dpp v8, v28 quad_perm:[0,0,0,0] row_mask:0xf bank_mask:0xf
    v_mov_b32_dpp v9, v30 quad_perm:[2,2,2,2] row_mask:0xf bank_mask:0xf
    v_mfma_f32_16x16x32_bf16 v[24:27], v[180:183], v[36:39], v[24:27]
    v_add_f32_dpp v8, v29, v8 quad_perm:[1,1,1,1] row_mask:0xf bank_mask:0xf
    v_add_f32_dpp v9, v31, v9 quad_perm:[3,3,3,3] row_mask:0xf bank_mask:0xf
    v_add_f32 v8, v8, v9
    v_mfma_f32_16x16x32_bf16 v[24:27], v[184:187], v[40:43], v[24:27]
    v_cvt_pk_bf16_f32 v8, 0, v8
    v_mul_f32 v8, s47, v8
    v_mfma_f32_16x16x32_bf16 v[24:27], v[188:191], v[44:47], v[24:27]
    v_cvt_pk_bf16_f32 v69, 0, v8
    v_max_f32 v10, v10, v69
    s_waitcnt vmcnt(4)
    buffer_load_dwordx4 v[216:219], v2, s[36:39], s44 offen offset:2048 nt
    s_waitcnt vmcnt(4)
    buffer_load_dwordx4 v[220:223], v2, s[36:39], s44 offen offset:3072 nt
    s_waitcnt vmcnt(4)
    s_mov_b32 s44, 802816
    buffer_load_dwordx4 v[224:227], v2, s[36:39], s44 offen offset:0 nt
    v_mfma_f32_16x16x32_bf16 v[28:31], v[192:195], v[32:35], 0
    v_mov_b32_dpp v8, v24 quad_perm:[0,0,0,0] row_mask:0xf bank_mask:0xf
    v_mov_b32_dpp v9, v26 quad_perm:[2,2,2,2] row_mask:0xf bank_mask:0xf
    v_mfma_f32_16x16x32_bf16 v[28:31], v[196:199], v[36:39], v[28:31]
    v_add_f32_dpp v8, v25, v8 quad_perm:[1,1,1,1] row_mask:0xf bank_mask:0xf
    v_add_f32_dpp v9, v27, v9 quad_perm:[3,3,3,3] row_mask:0xf bank_mask:0xf
    v_add_f32 v8, v8, v9
    v_mfma_f32_16x16x32_bf16 v[28:31], v[200:203], v[40:43], v[28:31]
    v_cvt_pk_bf16_f32 v8, 0, v8
    v_mul_f32 v8, s47, v8
    v_mfma_f32_16x16x32_bf16 v[28:31], v[204:207], v[44:47], v[28:31]
    v_cvt_pk_bf16_f32 v70, 0, v8
    v_max_f32 v10, v10, v70
    s_waitcnt vmcnt(4)
    buffer_load_dwordx4 v[228:231], v2, s[36:39], s44 offen offset:1024 nt
    s_waitcnt vmcnt(4)
    buffer_load_dwordx4 v[232:235], v2, s[36:39], s44 offen offset:2048 nt
    s_waitcnt vmcnt(4)
    buffer_load_dwordx4 v[236:239], v2, s[36:39], s44 offen offset:3072 nt
    s_waitcnt vmcnt(4)
    s_mov_b32 s44, 851968
    buffer_load_dwordx4 v[240:243], v2, s[36:39], s44 offen offset:0 nt
    v_mfma_f32_16x16x32_bf16 v[24:27], v[208:211], v[32:35], 0
    v_mov_b32_dpp v8, v28 quad_perm:[0,0,0,0] row_mask:0xf bank_mask:0xf
    v_mov_b32_dpp v9, v30 quad_perm:[2,2,2,2] row_mask:0xf bank_mask:0xf
    v_mfma_f32_16x16x32_bf16 v[24:27], v[212:215], v[36:39], v[24:27]
    v_add_f32_dpp v8, v29, v8 quad_perm:[1,1,1,1] row_mask:0xf bank_mask:0xf
    v_add_f32_dpp v9, v31, v9 quad_perm:[3,3,3,3] row_mask:0xf bank_mask:0xf
    v_add_f32 v8, v8, v9
    v_mfma_f32_16x16x32_bf16 v[24:27], v[216:219], v[40:43], v[24:27]
    v_cvt_pk_bf16_f32 v8, 0, v8
    v_mul_f32 v8, s47, v8
    v_mfma_f32_16x16x32_bf16 v[24:27], v[220:223], v[44:47], v[24:27]
    v_cvt_pk_bf16_f32 v71, 0, v8
    v_max_f32 v10, v10, v71
    s_waitcnt vmcnt(4)
    buffer_load_dwordx4 v[244:247], v2, s[36:39], s44 offen offset:1024 nt
    s_waitcnt vmcnt(4)
    buffer_load_dwordx4 v[248:251], v2, s[36:39], s44 offen offset:2048 nt
    s_waitcnt vmcnt(4)
    buffer_load_dwordx4 v[252:255], v2, s[36:39], s44 offen offset:3072 nt
    s_waitcnt vmcnt(4)
    s_mov_b32 s44, 868352
    buffer_load_dwordx4 v[80:83], v2, s[36:39], s44 offen offset:0 nt
    v_mfma_f32_16x16x32_bf16 v[28:31], v[224:227], v[32:35], 0
    v_mov_b32_dpp v8, v24 quad_perm:[0,0,0,0] row_mask:0xf bank_mask:0xf
    v_mov_b32_dpp v9, v26 quad_perm:[2,2,2,2] row_mask:0xf bank_mask:0xf
    v_mfma_f32_16x16x32_bf16 v[28:31], v[228:231], v[36:39], v[28:31]
    v_add_f32_dpp v8, v25, v8 quad_perm:[1,1,1,1] row_mask:0xf bank_mask:0xf
    v_add_f32_dpp v9, v27, v9 quad_perm:[3,3,3,3] row_mask:0xf bank_mask:0xf
    v_add_f32 v8, v8, v9
    v_mfma_f32_16x16x32_bf16 v[28:31], v[232:235], v[40:43], v[28:31]
    v_cvt_pk_bf16_f32 v8, 0, v8
    v_mul_f32 v8, s47, v8
    v_mfma_f32_16x16x32_bf16 v[28:31], v[236:239], v[44:47], v[28:31]
    v_cvt_pk_bf16_f32 v72, 0, v8
    v_max_f32 v10, v10, v72
    s_waitcnt vmcnt(4)
    buffer_load_dwordx4 v[84:87], v2, s[36:39], s44 offen offset:1024 nt
    s_waitcnt vmcnt(4)
    buffer_load_dwordx4 v[88:91], v2, s[36:39], s44 offen offset:2048 nt
    s_waitcnt vmcnt(4)
    buffer_load_dwordx4 v[92:95], v2, s[36:39], s44 offen offset:3072 nt
    s_waitcnt vmcnt(4)
    s_mov_b32 s44, 917504
    buffer_load_dwordx4 v[96:99], v2, s[36:39], s44 offen offset:0 nt
    v_mfma_f32_16x16x32_bf16 v[24:27], v[240:243], v[32:35], 0
    v_mov_b32_dpp v8, v28 quad_perm:[0,0,0,0] row_mask:0xf bank_mask:0xf
    v_mov_b32_dpp v9, v30 quad_perm:[2,2,2,2] row_mask:0xf bank_mask:0xf
    v_mfma_f32_16x16x32_bf16 v[24:27], v[244:247], v[36:39], v[24:27]
    v_add_f32_dpp v8, v29, v8 quad_perm:[1,1,1,1] row_mask:0xf bank_mask:0xf
    v_add_f32_dpp v9, v31, v9 quad_perm:[3,3,3,3] row_mask:0xf bank_mask:0xf
    v_add_f32 v8, v8, v9
    v_mfma_f32_16x16x32_bf16 v[24:27], v[248:251], v[40:43], v[24:27]
    v_cvt_pk_bf16_f32 v8, 0, v8
    v_mul_f32 v8, s47, v8
    v_mfma_f32_16x16x32_bf16 v[24:27], v[252:255], v[44:47], v[24:27]
    v_cvt_pk_bf16_f32 v73, 0, v8
    v_max_f32 v10, v10, v73
    s_waitcnt vmcnt(4)
    buffer_load_dwordx4 v[100:103], v2, s[36:39], s44 offen offset:1024 nt
    s_waitcnt vmcnt(4)
    buffer_load_dwordx4 v[104:107], v2, s[36:39], s44 offen offset:2048 nt
    s_waitcnt vmcnt(4)
    buffer_load_dwordx4 v[108:111], v2, s[36:39], s44 offen offset:3072 nt
    s_waitcnt vmcnt(4)
    s_mov_b32 s44, 933888
    buffer_load_dwordx4 v[112:115], v2, s[36:39], s44 offen offset:0 nt
    v_mfma_f32_16x16x32_bf16 v[28:31], v[80:83], v[32:35], 0
    v_mov_b32_dpp v8, v24 quad_perm:[0,0,0,0] row_mask:0xf bank_mask:0xf
    v_mov_b32_dpp v9, v26 quad_perm:[2,2,2,2] row_mask:0xf bank_mask:0xf
    v_mfma_f32_16x16x32_bf16 v[28:31], v[84:87], v[36:39], v[28:31]
    v_add_f32_dpp v8, v25, v8 quad_perm:[1,1,1,1] row_mask:0xf bank_mask:0xf
    v_add_f32_dpp v9, v27, v9 quad_perm:[3,3,3,3] row_mask:0xf bank_mask:0xf
    v_add_f32 v8, v8, v9
    v_mfma_f32_16x16x32_bf16 v[28:31], v[88:91], v[40:43], v[28:31]
    v_cvt_pk_bf16_f32 v8, 0, v8
    v_mul_f32 v8, s47, v8
    v_mfma_f32_16x16x32_bf16 v[28:31], v[92:95], v[44:47], v[28:31]
    v_cvt_pk_bf16_f32 v74, 0, v8
    v_max_f32 v10, v10, v74
    s_waitcnt vmcnt(4)
    buffer_load_dwordx4 v[116:119], v2, s[36:39], s44 offen offset:1024 nt
    s_waitcnt vmcnt(4)
    buffer_load_dwordx4 v[120:123], v2, s[36:39], s44 offen offset:2048 nt
    s_waitcnt vmcnt(4)
    buffer_load_dwordx4 v[124:127], v2, s[36:39], s44 offen offset:3072 nt
    s_waitcnt vmcnt(4)
    s_mov_b32 s44, 983040
    buffer_load_dwordx4 v[128:131], v2, s[36:39], s44 offen offset:0 nt
    v_mfma_f32_16x16x32_bf16 v[24:27], v[96:99], v[32:35], 0
    v_mov_b32_dpp v8, v28 quad_perm:[0,0,0,0] row_mask:0xf bank_mask:0xf
    v_mov_b32_dpp v9, v30 quad_perm:[2,2,2,2] row_mask:0xf bank_mask:0xf
    v_mfma_f32_16x16x32_bf16 v[24:27], v[100:103], v[36:39], v[24:27]
    v_add_f32_dpp v8, v29, v8 quad_perm:[1,1,1,1] row_mask:0xf bank_mask:0xf
    v_add_f32_dpp v9, v31, v9 quad_perm:[3,3,3,3] row_mask:0xf bank_mask:0xf
    v_add_f32 v8, v8, v9
    v_mfma_f32_16x16x32_bf16 v[24:27], v[104:107], v[40:43], v[24:27]
    v_cvt_pk_bf16_f32 v8, 0, v8
    v_mul_f32 v8, s47, v8
    v_mfma_f32_16x16x32_bf16 v[24:27], v[108:111], v[44:47], v[24:27]
    v_cvt_pk_bf16_f32 v75, 0, v8
    v_max_f32 v10, v10, v75
    s_waitcnt vmcnt(4)
    buffer_load_dwordx4 v[132:135], v2, s[36:39], s44 offen offset:1024 nt
    s_waitcnt vmcnt(4)
    buffer_load_dwordx4 v[136:139], v2, s[36:39], s44 offen offset:2048 nt
    s_waitcnt vmcnt(4)
    buffer_load_dwordx4 v[140:143], v2, s[36:39], s44 offen offset:3072 nt
    s_waitcnt vmcnt(4)
    s_mov_b32 s44, 999424
    buffer_load_dwordx4 v[144:147], v2, s[36:39], s44 offen offset:0 nt
    v_mfma_f32_16x16x32_bf16 v[28:31], v[112:115], v[32:35], 0
    v_mov_b32_dpp v8, v24 quad_perm:[0,0,0,0] row_mask:0xf bank_mask:0xf
    v_mov_b32_dpp v9, v26 quad_perm:[2,2,2,2] row_mask:0xf bank_mask:0xf
    v_mfma_f32_16x16x32_bf16 v[28:31], v[116:119], v[36:39], v[28:31]
    v_add_f32_dpp v8, v25, v8 quad_perm:[1,1,1,1] row_mask:0xf bank_mask:0xf
    v_add_f32_dpp v9, v27, v9 quad_perm:[3,3,3,3] row_mask:0xf bank_mask:0xf
    v_add_f32 v8, v8, v9
    v_mfma_f32_16x16x32_bf16 v[28:31], v[120:123], v[40:43], v[28:31]
    v_cvt_pk_bf16_f32 v8, 0, v8
    v_mul_f32 v8, s47, v8
    v_mfma_f32_16x16x32_bf16 v[28:31], v[124:127], v[44:47], v[28:31]
    v_cvt_pk_bf16_f32 v76, 0, v8
    v_max_f32 v10, v10, v76
    s_waitcnt vmcnt(4)
    buffer_load_dwordx4 v[148:151], v2, s[36:39], s44 offen offset:1024 nt
    s_waitcnt vmcnt(4)
    buffer_load_dwordx4 v[152:155], v2, s[36:39], s44 offen offset:2048 nt
    s_waitcnt vmcnt(4)
    buffer_load_dwordx4 v[156:159], v2, s[36:39], s44 offen offset:3072 nt
    s_waitcnt vmcnt(4)
    s_mov_b32 s44, 0
    buffer_load_dwordx4 v[160:163], v3, s[40:43], s44 offen offset:0 nt
    v_mfma_f32_16x16x32_bf16 v[24:27], v[128:131], v[32:35], 0
    v_mov_b32_dpp v8, v28 quad_perm:[0,0,0,0] row_mask:0xf bank_mask:0xf
    v_mov_b32_dpp v9, v30 quad_perm:[2,2,2,2] row_mask:0xf bank_mask:0xf
    v_mfma_f32_16x16x32_bf16 v[24:27], v[132:135], v[36:39], v[24:27]
    v_add_f32_dpp v8, v29, v8 quad_perm:[1,1,1,1] row_mask:0xf bank_mask:0xf
    v_add_f32_dpp v9, v31, v9 quad_perm:[3,3,3,3] row_mask:0xf bank_mask:0xf
    v_add_f32 v8, v8, v9
    v_mfma_f32_16x16x32_bf16 v[24:27], v[136:139], v[40:43], v[24:27]
    v_cvt_pk_bf16_f32 v8, 0, v8
    v_mul_f32 v8, s47, v8
    v_mfma_f32_16x16x32_bf16 v[24:27], v[140:143], v[44:47], v[24:27]
    v_cvt_pk_bf16_f32 v77, 0, v8
    v_max_f32 v10, v10, v77
    s_waitcnt vmcnt(4)
    buffer_load_dwordx4 v[164:167], v3, s[40:43], s44 offen offset:1024 nt
    s_waitcnt vmcnt(4)
    buffer_load_dwordx4 v[168:171], v3, s[40:43], s44 offen offset:2048 nt
    s_waitcnt vmcnt(4)
    buffer_load_dwordx4 v[172:175], v3, s[40:43], s44 offen offset:3072 nt
    s_waitcnt vmcnt(4)
    s_mov_b32 s44, 16384
    buffer_load_dwordx4 v[176:179], v3, s[40:43], s44 offen offset:0 nt
    v_mfma_f32_16x16x32_bf16 v[28:31], v[144:147], v[32:35], 0
    v_mov_b32_dpp v8, v24 quad_perm:[0,0,0,0] row_mask:0xf bank_mask:0xf
    v_mov_b32_dpp v9, v26 quad_perm:[2,2,2,2] row_mask:0xf bank_mask:0xf
    v_mfma_f32_16x16x32_bf16 v[28:31], v[148:151], v[36:39], v[28:31]
    v_add_f32_dpp v8, v25, v8 quad_perm:[1,1,1,1] row_mask:0xf bank_mask:0xf
    v_add_f32_dpp v9, v27, v9 quad_perm:[3,3,3,3] row_mask:0xf bank_mask:0xf
    v_add_f32 v8, v8, v9
    v_mfma_f32_16x16x32_bf16 v[28:31], v[152:155], v[40:43], v[28:31]
    v_cvt_pk_bf16_f32 v8, 0, v8
    v_mul_f32 v8, s47, v8
    v_mfma_f32_16x16x32_bf16 v[28:31], v[156:159], v[44:47], v[28:31]
    v_cvt_pk_bf16_f32 v78, 0, v8
    v_max_f32 v10, v10, v78
    s_waitcnt vmcnt(4)
    buffer_load_dwordx4 v[180:183], v3, s[40:43], s44 offen offset:1024 nt
    s_nop 3
    v_mov_b32_dpp v8, v28 quad_perm:[0,0,0,0] row_mask:0xf bank_mask:0xf
    v_mov_b32_dpp v9, v30 quad_perm:[2,2,2,2] row_mask:0xf bank_mask:0xf
    s_nop 0
    v_add_f32_dpp v8, v29, v8 quad_perm:[1,1,1,1] row_mask:0xf bank_mask:0xf
    v_add_f32_dpp v9, v31, v9 quad_perm:[3,3,3,3] row_mask:0xf bank_mask:0xf
    v_add_f32 v8, v8, v9
    v_cvt_pk_bf16_f32 v8, 0, v8
    v_mul_f32 v8, s47, v8
    v_cvt_pk_bf16_f32 v79, 0, v8
    v_max_f32 v10, v10, v79
    s_nop 1
    v_max_f32_dpp v10, v10, v10 row_ror:4 row_mask:0xf bank_mask:0xf
    s_nop 1
    v_max_f32_dpp v10, v10, v10 row_ror:8 row_mask:0xf bank_mask:0xf
    v_mov_b32 v8, v10
    s_nop 1
    v_permlane16_swap_b32 v10, v8
    v_max_f32 v10, v10, v8
    v_mov_b32 v8, v10
    s_nop 1
    v_permlane32_swap_b32 v10, v8
    v_max_f32 v10, v10, v8
    v_sub_f32 v8, v48, v10
    v_mul_f32 v8, s48, v8
    v_exp_f32 v8, v8
    s_nop 0
    v_add_f32 v11, v11, v8
    v_cvt_pk_bf16_f32 v48, v8, v8
    s_nop 1
    v_and_b32_dpp v32, v48, v16 row_newbcast:0 row_mask:0xf bank_mask:0xf
    v_and_b32_dpp v33, v48, v17 row_newbcast:0 row_mask:0xf bank_mask:0xf
    v_and_b32_dpp v34, v48, v18 row_newbcast:0 row_mask:0xf bank_mask:0xf
    v_and_b32_dpp v35, v48, v19 row_newbcast:0 row_mask:0xf bank_mask:0xf
    v_sub_f32 v8, v49, v10
    v_mul_f32 v8, s48, v8
    v_exp_f32 v8, v8
    s_nop 0
    v_add_f32 v11, v11, v8
    v_cvt_pk_bf16_f32 v49, v8, v8
    v_mfma_f32_16x16x32_bf16 v[20:23], v[32:35], v[160:163], 0
    v_and_b32_dpp v36, v48, v16 row_newbcast:4 row_mask:0xf bank_mask:0xf
    v_and_b32_dpp v37, v48, v17 row_newbcast:4 row_mask:0xf bank_mask:0xf
    v_and_b32_dpp v38, v48, v18 row_newbcast:4 row_mask:0xf bank_mask:0xf
    v_and_b32_dpp v39, v48, v19 row_newbcast:4 row_mask:0xf bank_mask:0xf
    v_sub_f32 v8, v50, v10
    v_mul_f32 v8, s48, v8
    v_exp_f32 v8, v8
    s_nop 0
    v_add_f32 v11, v11, v8
    v_cvt_pk_bf16_f32 v50, v8, v8
    s_waitcnt vmcnt(4)
    buffer_load_dwordx4 v[184:187], v3, s[40:43], s44 offen offset:2048 nt
    v_mfma_f32_16x16x32_bf16 v[20:23], v[36:39], v[164:167], v[20:23]
    v_and_b32_dpp v40, v48, v16 row_newbcast:8 row_mask:0xf bank_mask:0xf
    v_and_b32_dpp v41, v48, v17 row_newbcast:8 row_mask:0xf bank_mask:0xf
    v_and_b32_dpp v42, v48, v18 row_newbcast:8 row_mask:0xf bank_mask:0xf
    v_and_b32_dpp v43, v48, v19 row_newbcast:8 row_mask:0xf bank_mask:0xf
    v_sub_f32 v8, v51, v10
    v_mul_f32 v8, s48, v8
    v_exp_f32 v8, v8
    s_nop 0
    v_add_f32 v11, v11, v8
    v_cvt_pk_bf16_f32 v51, v8, v8
    s_waitcnt vmcnt(4)
    buffer_load_dwordx4 v[188:191], v3, s[40:43], s44 offen offset:3072 nt
    v_mfma_f32_16x16x32_bf16 v[20:23], v[40:43], v[168:171], v[20:23]
    v_and_b32_dpp v44, v48, v16 row_newbcast:12 row_mask:0xf bank_mask:0xf
    v_and_b32_dpp v45, v48, v17 row_newbcast:12 row_mask:0xf bank_mask:0xf
    v_and_b32_dpp v46, v48, v18 row_newbcast:12 row_mask:0xf bank_mask:0xf
    v_and_b32_dpp v47, v48, v19 row_newbcast:12 row_mask:0xf bank_mask:0xf
    v_sub_f32 v8, v52, v10
    v_mul_f32 v8, s48, v8
    v_exp_f32 v8, v8
    s_nop 0
    v_add_f32 v11, v11, v8
    v_cvt_pk_bf16_f32 v52, v8, v8
    s_waitcnt vmcnt(4)
    s_mov_b32 s44, 65536
    buffer_load_dwordx4 v[192:195], v3, s[40:43], s44 offen offset:0 nt
    v_mfma_f32_16x16x32_bf16 v[20:23], v[44:47], v[172:175], v[20:23]
    v_and_b32_dpp v32, v49, v16 row_newbcast:0 row_mask:0xf bank_mask:0xf
    v_and_b32_dpp v33, v49, v17 row_newbcast:0 row_mask:0xf bank_mask:0xf
    v_and_b32_dpp v34, v49, v18 row_newbcast:0 row_mask:0xf bank_mask:0xf
    v_and_b32_dpp v35, v49, v19 row_newbcast:0 row_mask:0xf bank_mask:0xf
    v_sub_f32 v8, v53, v10
    v_mul_f32 v8, s48, v8
    v_exp_f32 v8, v8
    s_nop 0
    v_add_f32 v11, v11, v8
    v_cvt_pk_bf16_f32 v53, v8, v8
    s_waitcnt vmcnt(4)
    buffer_load_dwordx4 v[196:199], v3, s[40:43], s44 offen offset:1024 nt
    v_mfma_f32_16x16x32_bf16 v[20:23], v[32:35], v[176:179], v[20:23]
    v_and_b32_dpp v36, v49, v16 row_newbcast:4 row_mask:0xf bank_mask:0xf
    v_and_b32_dpp v37, v49, v17 row_newbcast:4 row_mask:0xf bank_mask:0xf
    v_and_b32_dpp v38, v49, v18 row_newbcast:4 row_mask:0xf bank_mask:0xf
    v_and_b32_dpp v39, v49, v19 row_newbcast:4 row_mask:0xf bank_mask:0xf
    v_sub_f32 v8, v54, v10
    v_mul_f32 v8, s48, v8
    v_exp_f32 v8, v8
    s_nop 0
    v_add_f32 v11, v11, v8
    v_cvt_pk_bf16_f32 v54, v8, v8
    s_waitcnt vmcnt(4)
    buffer_load_dwordx4 v[200:203], v3, s[40:43], s44 offen offset:2048 nt
    v_mfma_f32_16x16x32_bf16 v[20:23], v[36:39], v[180:183], v[20:23]
    v_and_b32_dpp v40, v49, v16 row_newbcast:8 row_mask:0xf bank_mask:0xf
    v_and_b32_dpp v41, v49, v17 row_newbcast:8 row_mask:0xf bank_mask:0xf
    v_and_b32_dpp v42, v49, v18 row_newbcast:8 row_mask:0xf bank_mask:0xf
    v_and_b32_dpp v43, v49, v19 row_newbcast:8 row_mask:0xf bank_mask:0xf
    v_sub_f32 v8, v55, v10
    v_mul_f32 v8, s48, v8
    v_exp_f32 v8, v8
    s_nop 0
    v_add_f32 v11, v11, v8
    v_cvt_pk_bf16_f32 v55, v8, v8
    s_waitcnt vmcnt(4)
    buffer_load_dwordx4 v[204:207], v3, s[40:43], s44 offen offset:3072 nt
    v_mfma_f32_16x16x32_bf16 v[20:23], v[40:43], v[184:187], v[20:23]
    v_and_b32_dpp v44, v49, v16 row_newbcast:12 row_mask:0xf bank_mask:0xf
    v_and_b32_dpp v45, v49, v17 row_newbcast:12 row_mask:0xf bank_mask:0xf
    v_and_b32_dpp v46, v49, v18 row_newbcast:12 row_mask:0xf bank_mask:0xf
    v_and_b32_dpp v47, v49, v19 row_newbcast:12 row_mask:0xf bank_mask:0xf
    v_sub_f32 v8, v56, v10
    v_mul_f32 v8, s48, v8
    v_exp_f32 v8, v8
    s_nop 0
    v_add_f32 v11, v11, v8
    v_cvt_pk_bf16_f32 v56, v8, v8
    s_waitcnt vmcnt(4)
    s_mov_b32 s44, 81920
    buffer_load_dwordx4 v[208:211], v3, s[40:43], s44 offen offset:0 nt
    buffer_load_dword v30, v13, s[56:59], 0 offen offset:0 sc1
    v_mfma_f32_16x16x32_bf16 v[20:23], v[44:47], v[188:191], v[20:23]
    v_and_b32_dpp v32, v50, v16 row_newbcast:0 row_mask:0xf bank_mask:0xf
    v_and_b32_dpp v33, v50, v17 row_newbcast:0 row_mask:0xf bank_mask:0xf
    v_and_b32_dpp v34, v50, v18 row_newbcast:0 row_mask:0xf bank_mask:0xf
    v_and_b32_dpp v35, v50, v19 row_newbcast:0 row_mask:0xf bank_mask:0xf
    v_sub_f32 v8, v57, v10
    v_mul_f32 v8, s48, v8
    v_exp_f32 v8, v8
    s_nop 0
    v_add_f32 v11, v11, v8
    v_cvt_pk_bf16_f32 v57, v8, v8
    s_waitcnt vmcnt(5)
    buffer_load_dwordx4 v[212:215], v3, s[40:43], s44 offen offset:1024 nt
    v_mfma_f32_16x16x32_bf16 v[20:23], v[32:35], v[192:195], v[20:23]
    v_and_b32_dpp v36, v50, v16 row_newbcast:4 row_mask:0xf bank_mask:0xf
    v_and_b32_dpp v37, v50, v17 row_newbcast:4 row_mask:0xf bank_mask:0xf
    v_and_b32_dpp v38, v50, v18 row_newbcast:4 row_mask:0xf bank_mask:0xf
    v_and_b32_dpp v39, v50, v19 row_newbcast:4 row_mask:0xf bank_mask:0xf
    v_sub_f32 v8, v58, v10
    v_mul_f32 v8, s48, v8
    v_exp_f32 v8, v8
    s_nop 0
    v_add_f32 v11, v11, v8
    v_cvt_pk_bf16_f32 v58, v8, v8
    s_waitcnt vmcnt(5)
    buffer_load_dwordx4 v[216:219], v3, s[40:43], s44 offen offset:2048 nt
    buffer_load_dword v31, v13, s[56:59], 0 offen offset:0 sc1
    v_mfma_f32_16x16x32_bf16 v[20:23], v[36:39], v[196:199], v[20:23]
    v_and_b32_dpp v40, v50, v16 row_newbcast:8 row_mask:0xf bank_mask:0xf
    v_and_b32_dpp v41, v50, v17 row_newbcast:8 row_mask:0xf bank_mask:0xf
    v_and_b32_dpp v42, v50, v18 row_newbcast:8 row_mask:0xf bank_mask:0xf
    v_and_b32_dpp v43, v50, v19 row_newbcast:8 row_mask:0xf bank_mask:0xf
    v_sub_f32 v8, v59, v10
    v_mul_f32 v8, s48, v8
    v_exp_f32 v8, v8
    s_nop 0
    v_add_f32 v11, v11, v8
    v_cvt_pk_bf16_f32 v59, v8, v8
    s_waitcnt vmcnt(6)
    buffer_load_dwordx4 v[220:223], v3, s[40:43], s44 offen offset:3072 nt
    v_mfma_f32_16x16x32_bf16 v[20:23], v[40:43], v[200:203], v[20:23]
    v_and_b32_dpp v44, v50, v16 row_newbcast:12 row_mask:0xf bank_mask:0xf
    v_and_b32_dpp v45, v50, v17 row_newbcast:12 row_mask:0xf bank_mask:0xf
    v_and_b32_dpp v46, v50, v18 row_newbcast:12 row_mask:0xf bank_mask:0xf
    v_and_b32_dpp v47, v50, v19 row_newbcast:12 row_mask:0xf bank_mask:0xf
    v_sub_f32 v8, v60, v10
    v_mul_f32 v8, s48, v8
    v_exp_f32 v8, v8
    s_nop 0
    v_add_f32 v11, v11, v8
    v_cvt_pk_bf16_f32 v60, v8, v8
    s_waitcnt vmcnt(6)
    s_mov_b32 s44, 131072
    buffer_load_dwordx4 v[224:227], v3, s[40:43], s44 offen offset:0 nt
    buffer_load_dword v24, v13, s[56:59], 0 offen offset:0 sc1
    v_mfma_f32_16x16x32_bf16 v[20:23], v[44:47], v[204:207], v[20:23]
    v_and_b32_dpp v32, v51, v16 row_newbcast:0 row_mask:0xf bank_mask:0xf
    v_and_b32_dpp v33, v51, v17 row_newbcast:0 row_mask:0xf bank_mask:0xf
    v_and_b32_dpp v34, v51, v18 row_newbcast:0 row_mask:0xf bank_mask:0xf
    v_and_b32_dpp v35, v51, v19 row_newbcast:0 row_mask:0xf bank_mask:0xf
    v_sub_f32 v8, v61, v10
    v_mul_f32 v8, s48, v8
    v_exp_f32 v8, v8
    s_nop 0
    v_add_f32 v11, v11, v8
    v_cvt_pk_bf16_f32 v61, v8, v8
    s_waitcnt vmcnt(7)
    buffer_load_dwordx4 v[228:231], v3, s[40:43], s44 offen offset:1024 nt
    v_mfma_f32_16x16x32_bf16 v[20:23], v[32:35], v[208:211], v[20:23]
    v_and_b32_dpp v36, v51, v16 row_newbcast:4 row_mask:0xf bank_mask:0xf
    v_and_b32_dpp v37, v51, v17 row_newbcast:4 row_mask:0xf bank_mask:0xf
    v_and_b32_dpp v38, v51, v18 row_newbcast:4 row_mask:0xf bank_mask:0xf
    v_and_b32_dpp v39, v51, v19 row_newbcast:4 row_mask:0xf bank_mask:0xf
    v_sub_f32 v8, v62, v10
    v_mul_f32 v8, s48, v8
    v_exp_f32 v8, v8
    s_nop 0
    v_add_f32 v11, v11, v8
    v_cvt_pk_bf16_f32 v62, v8, v8
    s_waitcnt vmcnt(6)
    v_cmp_eq_u32 vcc, v14, v30
    s_nop 0
    s_bcnt1_i32_b32 s69, vcc_lo
    s_cmp_ge_u32 s69, 16
    s_cselect_b32 s69, 220, 0
    s_max_u32 s68, s68, s69
    buffer_load_dwordx4 v[232:235], v3, s[40:43], s44 offen offset:2048 nt
    buffer_load_dword v25, v13, s[56:59], 0 offen offset:0 sc1
    v_mfma_f32_16x16x32_bf16 v[20:23], v[36:39], v[212:215], v[20:23]
    v_and_b32_dpp v40, v51, v16 row_newbcast:8 row_mask:0xf bank_mask:0xf
    v_and_b32_dpp v41, v51, v17 row_newbcast:8 row_mask:0xf bank_mask:0xf
    v_and_b32_dpp v42, v51, v18 row_newbcast:8 row_mask:0xf bank_mask:0xf
    v_and_b32_dpp v43, v51, v19 row_newbcast:8 row_mask:0xf bank_mask:0xf
    v_sub_f32 v8, v63, v10
    v_mul_f32 v8, s48, v8
    v_exp_f32 v8, v8
    s_nop 0
    v_add_f32 v11, v11, v8
    v_cvt_pk_bf16_f32 v63, v8, v8
    s_waitcnt vmcnt(7)
    buffer_load_dwordx4 v[236:239], v3, s[40:43], s44 offen offset:3072 nt
    s_cmpk_gt_u32 s68, 148
    s_cbranch_scc1 L_d148
    s_waitcnt vmcnt(6)
L_d148:
    s_mov_b32 s44, 147456
    buffer_load_dwordx4 v[240:243], v3, s[40:43], s44 offen offset:0 nt
    buffer_load_dword v26, v13, s[56:59], 0 offen offset:0 sc1
    s_cmpk_gt_u32 s68, 149
    s_cbranch_scc1 L_d149
    s_waitcnt vmcnt(7)
L_d149:
    buffer_load_dwordx4 v[244:247], v3, s[40:43], s44 offen offset:1024 nt
    s_cmpk_gt_u32 s68, 150
    s_cbranch_scc1 L_d150
    s_waitcnt vmcnt(6)
L_d150:
    buffer_load_dwordx4 v[248:251], v3, s[40:43], s44 offen offset:2048 nt
    buffer_load_dword v27, v13, s[56:59], 0 offen offset:0 sc1
    v_mfma_f32_16x16x32_bf16 v[20:23], v[40:43], v[216:219], v[20:23]
    v_and_b32_dpp v44, v51, v16 row_newbcast:12 row_mask:0xf bank_mask:0xf
    v_and_b32_dpp v45, v51, v17 row_newbcast:12 row_mask:0xf bank_mask:0xf
    v_and_b32_dpp v46, v51, v18 row_newbcast:12 row_mask:0xf bank_mask:0xf
    v_and_b32_dpp v47, v51, v19 row_newbcast:12 row_mask:0xf bank_mask:0xf
    v_sub_f32 v8, v64, v10
    v_mul_f32 v8, s48, v8
    v_exp_f32 v8, v8
    s_nop 0
    v_add_f32 v11, v11, v8
    v_cvt_pk_bf16_f32 v64, v8, v8
    s_waitcnt vmcnt(11)
    v_cmp_eq_u32 vcc, v14, v31
    s_nop 0
    s_bcnt1_i32_b32 s69, vcc_lo
    s_cmp_ge_u32 s69, 16
    s_cselect_b32 s69, 214, 0
    s_max_u32 s68, s68, s69
    s_cmpk_gt_u32 s68, 151
    s_cbranch_scc1 L_d151
    s_waitcnt vmcnt(7)
L_d151:
    buffer_load_dwordx4 v[252:255], v3, s[40:43], s44 offen offset:3072 nt
    v_mfma_f32_16x16x32_bf16 v[20:23], v[44:47], v[220:223], v[20:23]
    v_and_b32_dpp v32, v52, v16 row_newbcast:0 row_mask:0xf bank_mask:0xf
    v_and_b32_dpp v33, v52, v17 row_newbcast:0 row_mask:0xf bank_mask:0xf
    v_and_b32_dpp v34, v52, v18 row_newbcast:0 row_mask:0xf bank_mask:0xf
    v_and_b32_dpp v35, v52, v19 row_newbcast:0 row_mask:0xf bank_mask:0xf
    v_sub_f32 v8, v65, v10
    v_mul_f32 v8, s48, v8
    v_exp_f32 v8, v8
    s_nop 0
    v_add_f32 v11, v11, v8
    v_cvt_pk_bf16_f32 v65, v8, v8
    s_waitcnt vmcnt(11)
    s_cmpk_gt_u32 s68, 152
    s_cbranch_scc1 L_d152
    s_waitcnt vmcnt(6)
L_d152:
    s_mov_b32 s44, 196608
    buffer_load_dwordx4 v[80:83], v3, s[40:43], s44 offen offset:0 nt
    buffer_load_dword v28, v13, s[56:59], 0 offen offset:0 sc1
    v_mfma_f32_16x16x32_bf16 v[20:23], v[32:35], v[224:227], v[20:23]
    v_and_b32_dpp v36, v52, v16 row_newbcast:4 row_mask:0xf bank_mask:0xf
    v_and_b32_dpp v37, v52, v17 row_newbcast:4 row_mask:0xf bank_mask:0xf
    v_and_b32_dpp v38, v52, v18 row_newbcast:4 row_mask:0xf bank_mask:0xf
    v_and_b32_dpp v39, v52, v19 row_newbcast:4 row_mask:0xf bank_mask:0xf
    v_sub_f32 v8, v66, v10
    v_mul_f32 v8, s48, v8
    v_exp_f32 v8, v8
    s_nop 0
    v_add_f32 v11, v11, v8
    v_cvt_pk_bf16_f32 v66, v8, v8
    s_waitcnt vmcnt(11)
    v_cmp_eq_u32 vcc, v14, v24
    s_nop 0
    s_bcnt1_i32_b32 s69, vcc_lo
    s_cmp_ge_u32 s69, 16
    s_cselect_b32 s69, 208, 0
    s_max_u32 s68, s68, s69
    s_cmpk_gt_u32 s68, 153
    s_cbranch_scc1 L_d153
    s_waitcnt vmcnt(7)
L_d153:
    buffer_load_dwordx4 v[84:87], v3, s[40:43], s44 offen offset:1024 nt
    v_mfma_f32_16x16x32_bf16 v[20:23], v[36:39], v[228:231], v[20:23]
    v_and_b32_dpp v40, v52, v16 row_newbcast:8 row_mask:0xf bank_mask:0xf
    v_and_b32_dpp v41, v52, v17 row_newbcast:8 row_mask:0xf bank_mask:0xf
    v_and_b32_dpp v42, v52, v18 row_newbcast:8 row_mask:0xf bank_mask:0xf
    v_and_b32_dpp v43, v52, v19 row_newbcast:8 row_mask:0xf bank_mask:0xf
    v_sub_f32 v8, v67, v10
    v_mul_f32 v8, s48, v8
    v_exp_f32 v8, v8
    s_nop 0
    v_add_f32 v11, v11, v8
    v_cvt_pk_bf16_f32 v67, v8, v8
    s_waitcnt vmcnt(11)
    s_cmpk_gt_u32 s68, 154
    s_cbranch_scc1 L_d154
    s_waitcnt vmcnt(6)
L_d154:
    buffer_load_dwordx4 v[88:91], v3, s[40:43], s44 offen offset:2048 nt
    s_mov_b64 exec, 1
    buffer_store_dword v15, off, s[52:55], s71 offset:0 sc1
    s_mov_b64 exec, -1
    buffer_load_dword v29, v13, s[56:59], 0 offen offset:0 sc1
    v_mfma_f32_16x16x32_bf16 v[20:23], v[40:43], v[232:235], v[20:23]
    v_and_b32_dpp v44, v52, v16 row_newbcast:12 row_mask:0xf bank_mask:0xf
    v_and_b32_dpp v45, v52, v17 row_newbcast:12 row_mask:0xf bank_mask:0xf
    v_and_b32_dpp v46, v52, v18 row_newbcast:12 row_mask:0xf bank_mask:0xf
    v_and_b32_dpp v47, v52, v19 row_newbcast:12 row_mask:0xf bank_mask:0xf
    v_sub_f32 v8, v68, v10
    v_mul_f32 v8, s48, v8
    v_exp_f32 v8, v8
    s_nop 0
    v_add_f32 v11, v11, v8
    v_cvt_pk_bf16_f32 v68, v8, v8
    s_waitcnt vmcnt(12)
    v_cmp_eq_u32 vcc, v14, v25
    s_nop 0
    s_bcnt1_i32_b32 s69, vcc_lo
    s_cmp_ge_u32 s69, 16
    s_cselect_b32 s69, 202, 0
    s_max_u32 s68, s68, s69
    s_cmpk_gt_u32 s68, 155
    s_cbranch_scc1 L_d155
    s_waitcnt vmcnt(8)
L_d155:
    buffer_load_dwordx4 v[92:95], v3, s[40:43], s44 offen offset:3072 nt
    v_mfma_f32_16x16x32_bf16 v[20:23], v[44:47], v[236:239], v[20:23]
    v_and_b32_dpp v32, v53, v16 row_newbcast:0 row_mask:0xf bank_mask:0xf
    v_and_b32_dpp v33, v53, v17 row_newbcast:0 row_mask:0xf bank_mask:0xf
    v_and_b32_dpp v34, v53, v18 row_newbcast:0 row_mask:0xf bank_mask:0xf
    v_and_b32_dpp v35, v53, v19 row_newbcast:0 row_mask:0xf bank_mask:0xf
    v_sub_f32 v8, v69, v10
    v_mul_f32 v8, s48, v8
    v_exp_f32 v8, v8
    s_nop 0
    v_add_f32 v11, v11, v8
    v_cvt_pk_bf16_f32 v69, v8, v8
    s_waitcnt vmcnt(12)
    s_cmpk_gt_u32 s68, 156
    s_cbranch_scc1 L_d156
    s_waitcnt vmcnt(7)
L_d156:
    s_mov_b32 s44, 212992
    buffer_load_dwordx4 v[96:99], v3, s[40:43], s44 offen offset:0 nt
    buffer_load_dword v30, v13, s[56:59], 0 offen offset:0 sc1
    v_mfma_f32_16x16x32_bf16 v[20:23], v[32:35], v[240:243], v[20:23]
    v_and_b32_dpp v36, v53, v16 row_newbcast:4 row_mask:0xf bank_mask:0xf
    v_and_b32_dpp v37, v53, v17 row_newbcast:4 row_mask:0xf bank_mask:0xf
    v_and_b32_dpp v38, v53, v18 row_newbcast:4 row_mask:0xf bank_mask:0xf
    v_and_b32_dpp v39, v53, v19 row_newbcast:4 row_mask:0xf bank_mask:0xf
    v_sub_f32 v8, v70, v10
    v_mul_f32 v8, s48, v8
    v_exp_f32 v8, v8
    s_nop 0
    v_add_f32 v11, v11, v8
    v_cvt_pk_bf16_f32 v70, v8, v8
    s_waitcnt vmcnt(12)
    v_cmp_eq_u32 vcc, v14, v26
    s_nop 0
    s_bcnt1_i32_b32 s69, vcc_lo
    s_cmp_ge_u32 s69, 16
    s_cselect_b32 s69, 196, 0
    s_max_u32 s68, s68, s69
    s_cmpk_gt_u32 s68, 157
    s_cbranch_scc1 L_d157
    s_waitcnt vmcnt(8)
L_d157:
    buffer_load_dwordx4 v[100:103], v3, s[40:43], s44 offen offset:1024 nt
    v_mfma_f32_16x16x32_bf16 v[20:23], v[36:39], v[244:247], v[20:23]
    v_and_b32_dpp v40, v53, v16 row_newbcast:8 row_mask:0xf bank_mask:0xf
    v_and_b32_dpp v41, v53, v17 row_newbcast:8 row_mask:0xf bank_mask:0xf
    v_and_b32_dpp v42, v53, v18 row_newbcast:8 row_mask:0xf bank_mask:0xf
    v_and_b32_dpp v43, v53, v19 row_newbcast:8 row_mask:0xf bank_mask:0xf
    v_sub_f32 v8, v71, v10
    v_mul_f32 v8, s48, v8
    v_exp_f32 v8, v8
    s_nop 0
    v_add_f32 v11, v11, v8
    v_cvt_pk_bf16_f32 v71, v8, v8
    s_waitcnt vmcnt(12)
    s_cmpk_gt_u32 s68, 158
    s_cbranch_scc1 L_d158
    s_waitcnt vmcnt(7)
L_d158:
    buffer_load_dwordx4 v[104:107], v3, s[40:43], s44 offen offset:2048 nt
    v_mfma_f32_16x16x32_bf16 v[20:23], v[40:43], v[248:251], v[20:23]
    v_and_b32_dpp v44, v53, v16 row_newbcast:12 row_mask:0xf bank_mask:0xf
    v_and_b32_dpp v45, v53, v17 row_newbcast:12 row_mask:0xf bank_mask:0xf
    v_and_b32_dpp v46, v53, v18 row_newbcast:12 row_mask:0xf bank_mask:0xf
    v_and_b32_dpp v47, v53, v19 row_newbcast:12 row_mask:0xf bank_mask:0xf
    v_sub_f32 v8, v72, v10
    v_mul_f32 v8, s48, v8
    v_exp_f32 v8, v8
    s_nop 0
    v_add_f32 v11, v11, v8
    v_cvt_pk_bf16_f32 v72, v8, v8
    s_waitcnt vmcnt(11)
    v_cmp_eq_u32 vcc, v14, v27
    s_nop 0
    s_bcnt1_i32_b32 s69, vcc_lo
    s_cmp_ge_u32 s69, 16
    s_cselect_b32 s69, 190, 0
    s_max_u32 s68, s68, s69
    s_cmpk_gt_u32 s68, 159
    s_cbranch_scc1 L_d159
    s_waitcnt vmcnt(7)
L_d159:
    buffer_load_dwordx4 v[108:111], v3, s[40:43], s44 offen offset:3072 nt
    v_mfma_f32_16x16x32_bf16 v[20:23], v[44:47], v[252:255], v[20:23]
    v_and_b32_dpp v32, v54, v16 row_newbcast:0 row_mask:0xf bank_mask:0xf
    v_and_b32_dpp v33, v54, v17 row_newbcast:0 row_mask:0xf bank_mask:0xf
    v_and_b32_dpp v34, v54, v18 row_newbcast:0 row_mask:0xf bank_mask:0xf
    v_and_b32_dpp v35, v54, v19 row_newbcast:0 row_mask:0xf bank_mask:0xf
    v_sub_f32 v8, v73, v10
    v_mul_f32 v8, s48, v8
    v_exp_f32 v8, v8
    s_nop 0
    v_add_f32 v11, v11, v8
    v_cvt_pk_bf16_f32 v73, v8, v8
    s_waitcnt vmcnt(11)
    s_cmpk_gt_u32 s68, 160
    s_cbranch_scc1 L_d160
    s_waitcnt vmcnt(5)
L_d160:
    s_mov_b32 s44, 262144
    buffer_load_dwordx4 v[112:115], v3, s[40:43], s44 offen offset:0 nt
    v_mfma_f32_16x16x32_bf16 v[20:23], v[32:35], v[80:83], v[20:23]
    v_and_b32_dpp v36, v54, v16 row_newbcast:4 row_mask:0xf bank_mask:0xf
    v_and_b32_dpp v37, v54, v17 row_newbcast:4 row_mask:0xf bank_mask:0xf
    v_and_b32_dpp v38, v54, v18 row_newbcast:4 row_mask:0xf bank_mask:0xf
    v_and_b32_dpp v39, v54, v19 row_newbcast:4 row_mask:0xf bank_mask:0xf
    v_sub_f32 v8, v74, v10
    v_mul_f32 v8, s48, v8
    v_exp_f32 v8, v8
    s_nop 0
    v_add_f32 v11, v11, v8
    v_cvt_pk_bf16_f32 v74, v8, v8
    s_waitcnt vmcnt(10)
    v_cmp_eq_u32 vcc, v14, v28
    s_nop 0
    s_bcnt1_i32_b32 s69, vcc_lo
    s_cmp_ge_u32 s69, 16
    s_cselect_b32 s69, 184, 0
    s_max_u32 s68, s68, s69
    s_cmpk_gt_u32 s68, 161
    s_cbranch_scc1 L_d161
    s_waitcnt vmcnt(5)
L_d161:
    buffer_load_dwordx4 v[116:119], v3, s[40:43], s44 offen offset:1024 nt
    v_mfma_f32_16x16x32_bf16 v[20:23], v[36:39], v[84:87], v[20:23]
    v_and_b32_dpp v40, v54, v16 row_newbcast:8 row_mask:0xf bank_mask:0xf
    v_and_b32_dpp v41, v54, v17 row_newbcast:8 row_mask:0xf bank_mask:0xf
    v_and_b32_dpp v42, v54, v18 row_newbcast:8 row_mask:0xf bank_mask:0xf
    v_and_b32_dpp v43, v54, v19 row_newbcast:8 row_mask:0xf bank_mask:0xf
    v_sub_f32 v8, v75, v10
    v_mul_f32 v8, s48, v8
    v_exp_f32 v8, v8
    s_nop 0
    v_add_f32 v11, v11, v8
    v_cvt_pk_bf16_f32 v75, v8, v8
    s_waitcnt vmcnt(10)
    s_cmpk_gt_u32 s68, 162
    s_cbranch_scc1 L_d162
    s_waitcnt vmcnt(4)
L_d162:
    buffer_load_dwordx4 v[120:123], v3, s[40:43], s44 offen offset:2048 nt
    v_mfma_f32_16x16x32_bf16 v[20:23], v[40:43], v[88:91], v[20:23]
    v_and_b32_dpp v44, v54, v16 row_newbcast:12 row_mask:0xf bank_mask:0xf
    v_and_b32_dpp v45, v54, v17 row_newbcast:12 row_mask:0xf bank_mask:0xf
    v_and_b32_dpp v46, v54, v18 row_newbcast:12 row_mask:0xf bank_mask:0xf
    v_and_b32_dpp v47, v54, v19 row_newbcast:12 row_mask:0xf bank_mask:0xf
    v_sub_f32 v8, v76, v10
    v_mul_f32 v8, s48, v8
    v_exp_f32 v8, v8
    s_nop 0
    v_add_f32 v11, v11, v8
    v_cvt_pk_bf16_f32 v76, v8, v8
    s_waitcnt vmcnt(8)
    v_cmp_eq_u32 vcc, v14, v29
    s_nop 0
    s_bcnt1_i32_b32 s69, vcc_lo
    s_cmp_ge_u32 s69, 16
    s_cselect_b32 s69, 178, 0
    s_max_u32 s68, s68, s69
    s_cmpk_gt_u32 s68, 163
    s_cbranch_scc1 L_d163
    s_waitcnt vmcnt(4)
L_d163:
    buffer_load_dwordx4 v[124:127], v3, s[40:43], s44 offen offset:3072 nt
    v_mfma_f32_16x16x32_bf16 v[20:23], v[44:47], v[92:95], v[20:23]
    v_and_b32_dpp v32, v55, v16 row_newbcast:0 row_mask:0xf bank_mask:0xf
    v_and_b32_dpp v33, v55, v17 row_newbcast:0 row_mask:0xf bank_mask:0xf
    v_and_b32_dpp v34, v55, v18 row_newbcast:0 row_mask:0xf bank_mask:0xf
    v_and_b32_dpp v35, v55, v19 row_newbcast:0 row_mask:0xf bank_mask:0xf
    v_sub_f32 v8, v77, v10
    v_mul_f32 v8, s48, v8
    v_exp_f32 v8, v8
    s_nop 0
    v_add_f32 v11, v11, v8
    v_cvt_pk_bf16_f32 v77, v8, v8
    s_waitcnt vmcnt(8)
    s_cmpk_gt_u32 s68, 164
    s_cbranch_scc1 L_d164
    s_waitcnt vmcnt(4)
L_d164:
    s_mov_b32 s44, 278528
    buffer_load_dwordx4 v[128:131], v3, s[40:43], s44 offen offset:0 nt
    v_mfma_f32_16x16x32_bf16 v[20:23], v[32:35], v[96:99], v[20:23]
    v_and_b32_dpp v36, v55, v16 row_newbcast:4 row_mask:0xf bank_mask:0xf
    v_and_b32_dpp v37, v55, v17 row_newbcast:4 row_mask:0xf bank_mask:0xf
    v_and_b32_dpp v38, v55, v18 row_newbcast:4 row_mask:0xf bank_mask:0xf
    v_and_b32_dpp v39, v55, v19 row_newbcast:4 row_mask:0xf bank_mask:0xf
    v_sub_f32 v8, v78, v10
    v_mul_f32 v8, s48, v8
    v_exp_f32 v8, v8
    s_nop 0
    v_add_f32 v11, v11, v8
    v_cvt_pk_bf16_f32 v78, v8, v8
    s_waitcnt vmcnt(7)
    v_cmp_eq_u32 vcc, v14, v30
    s_nop 0
    s_bcnt1_i32_b32 s69, vcc_lo
    s_cmp_ge_u32 s69, 16
    s_cselect_b32 s69, 172, 0
    s_max_u32 s68, s68, s69
    s_cmpk_gt_u32 s68, 165
    s_cbranch_scc1 L_d165
    s_waitcnt vmcnt(4)
L_d165:
    buffer_load_dwordx4 v[132:135], v3, s[40:43], s44 offen offset:1024 nt
    v_mfma_f32_16x16x32_bf16 v[20:23], v[36:39], v[100:103], v[20:23]
    v_and_b32_dpp v40, v55, v16 row_newbcast:8 row_mask:0xf bank_mask:0xf
    v_and_b32_dpp v41, v55, v17 row_newbcast:8 row_mask:0xf bank_mask:0xf
    v_and_b32_dpp v42, v55, v18 row_newbcast:8 row_mask:0xf bank_mask:0xf
    v_and_b32_dpp v43, v55, v19 row_newbcast:8 row_mask:0xf bank_mask:0xf
    v_sub_f32 v8, v79, v10
    v_mul_f32 v8, s48, v8
    v_exp_f32 v8, v8
    s_nop 0
    v_add_f32 v11, v11, v8
    v_cvt_pk_bf16_f32 v79, v8, v8
    s_waitcnt vmcnt(7)
    s_cmpk_gt_u32 s68, 166
    s_cbranch_scc1 L_d166
    s_waitcnt vmcnt(4)
L_d166:
    buffer_load_dwordx4 v[136:139], v3, s[40:43], s44 offen offset:2048 nt
    v_mfma_f32_16x16x32_bf16 v[20:23], v[40:43], v[104:107], v[20:23]
    v_and_b32_dpp v44, v55, v16 row_newbcast:12 row_mask:0xf bank_mask:0xf
    v_and_b32_dpp v45, v55, v17 row_newbcast:12 row_mask:0xf bank_mask:0xf
    v_and_b32_dpp v46, v55, v18 row_newbcast:12 row_mask:0xf bank_mask:0xf
    v_and_b32_dpp v47, v55, v19 row_newbcast:12 row_mask:0xf bank_mask:0xf
    v_add_f32_dpp v11, v11, v11 row_ror:4 row_mask:0xf bank_mask:0xf
    s_nop 1
    v_add_f32_dpp v11, v11, v11 row_ror:8 row_mask:0xf bank_mask:0xf
    v_mov_b32 v8, v11
    s_nop 1
    v_permlane16_swap_b32 v11, v8
    v_add_f32 v11, v11, v8
    v_mov_b32 v8, v11
    s_nop 1
    v_permlane32_swap_b32 v11, v8
    v_add_f32 v11, v11, v8
    v_min_u32 v10, -2, v10
    v_min_u32 v11, -2, v11
    ds_write_b64 v6, v[10:11]
    s_waitcnt vmcnt(7)
    s_cmpk_gt_u32 s68, 167
    s_cbranch_scc1 L_d167
    s_waitcnt vmcnt(4)
L_d167:
    buffer_load_dwordx4 v[140:143], v3, s[40:43], s44 offen offset:3072 nt
    v_mfma_f32_16x16x32_bf16 v[20:23], v[44:47], v[108:111], v[20:23]
    v_and_b32_dpp v32, v56, v16 row_newbcast:0 row_mask:0xf bank_mask:0xf
    v_and_b32_dpp v33, v56, v17 row_newbcast:0 row_mask:0xf bank_mask:0xf
    v_and_b32_dpp v34, v56, v18 row_newbcast:0 row_mask:0xf bank_mask:0xf
    v_and_b32_dpp v35, v56, v19 row_newbcast:0 row_mask:0xf bank_mask:0xf
    s_waitcnt vmcnt(7)
    s_cmpk_gt_u32 s68, 168
    s_cbranch_scc1 L_d168
    s_waitcnt vmcnt(4)
L_d168:
    s_mov_b32 s44, 327680
    buffer_load_dwordx4 v[144:147], v3, s[40:43], s44 offen offset:0 nt
    v_mfma_f32_16x16x32_bf16 v[20:23], v[32:35], v[112:115], v[20:23]
    v_and_b32_dpp v36, v56, v16 row_newbcast:4 row_mask:0xf bank_mask:0xf
    v_and_b32_dpp v37, v56, v17 row_newbcast:4 row_mask:0xf bank_mask:0xf
    v_and_b32_dpp v38, v56, v18 row_newbcast:4 row_mask:0xf bank_mask:0xf
    v_and_b32_dpp v39, v56, v19 row_newbcast:4 row_mask:0xf bank_mask:0xf
    s_waitcnt vmcnt(7)
    s_cmpk_gt_u32 s68, 169
    s_cbranch_scc1 L_d169
    s_waitcnt vmcnt(4)
L_d169:
    buffer_load_dwordx4 v[148:151], v3, s[40:43], s44 offen offset:1024 nt
    v_mfma_f32_16x16x32_bf16 v[20:23], v[36:39], v[116:119], v[20:23]
    v_and_b32_dpp v40, v56, v16 row_newbcast:8 row_mask:0xf bank_mask:0xf
    v_and_b32_dpp v41, v56, v17 row_newbcast:8 row_mask:0xf bank_mask:0xf
    v_and_b32_dpp v42, v56, v18 row_newbcast:8 row_mask:0xf bank_mask:0xf
    v_and_b32_dpp v43, v56, v19 row_newbcast:8 row_mask:0xf bank_mask:0xf
    s_waitcnt vmcnt(7)
    s_cmpk_gt_u32 s68, 170
    s_cbranch_scc1 L_d170
    s_waitcnt vmcnt(4)
L_d170:
    buffer_load_dwordx4 v[152:155], v3, s[40:43], s44 offen offset:2048 nt
    v_mfma_f32_16x16x32_bf16 v[20:23], v[40:43], v[120:123], v[20:23]
    v_and_b32_dpp v44, v56, v16 row_newbcast:12 row_mask:0xf bank_mask:0xf
    v_and_b32_dpp v45, v56, v17 row_newbcast:12 row_mask:0xf bank_mask:0xf
    v_and_b32_dpp v46, v56, v18 row_newbcast:12 row_mask:0xf bank_mask:0xf
    v_and_b32_dpp v47, v56, v19 row_newbcast:12 row_mask:0xf bank_mask:0xf
    s_waitcnt vmcnt(7)
    s_cmpk_gt_u32 s68, 171
    s_cbranch_scc1 L_d171
    s_waitcnt vmcnt(4)
L_d171:
    buffer_load_dwordx4 v[156:159], v3, s[40:43], s44 offen offset:3072 nt
    v_mfma_f32_16x16x32_bf16 v[20:23], v[44:47], v[124:127], v[20:23]
    v_and_b32_dpp v32, v57, v16 row_newbcast:0 row_mask:0xf bank_mask:0xf
    v_and_b32_dpp v33, v57, v17 row_newbcast:0 row_mask:0xf bank_mask:0xf
    v_and_b32_dpp v34, v57, v18 row_newbcast:0 row_mask:0xf bank_mask:0xf
    v_and_b32_dpp v35, v57, v19 row_newbcast:0 row_mask:0xf bank_mask:0xf
    s_waitcnt vmcnt(7)
    s_cmpk_gt_u32 s68, 172
    s_cbranch_scc1 L_d172
    s_waitcnt vmcnt(4)
L_d172:
    s_mov_b32 s44, 344064
    buffer_load_dwordx4 v[160:163], v3, s[40:43], s44 offen offset:0 nt
    v_mfma_f32_16x16x32_bf16 v[20:23], v[32:35], v[128:131], v[20:23]
    v_and_b32_dpp v36, v57, v16 row_newbcast:4 row_mask:0xf bank_mask:0xf
    v_and_b32_dpp v37, v57, v17 row_newbcast:4 row_mask:0xf bank_mask:0xf
    v_and_b32_dpp v38, v57, v18 row_newbcast:4 row_mask:0xf bank_mask:0xf
    v_and_b32_dpp v39, v57, v19 row_newbcast:4 row_mask:0xf bank_mask:0xf
    s_waitcnt vmcnt(7)
    s_cmpk_gt_u32 s68, 173
    s_cbranch_scc1 L_d173
    s_waitcnt vmcnt(4)
L_d173:
    buffer_load_dwordx4 v[164:167], v3, s[40:43], s44 offen offset:1024 nt
    v_mfma_f32_16x16x32_bf16 v[20:23], v[36:39], v[132:135], v[20:23]
    v_and_b32_dpp v40, v57, v16 row_newbcast:8 row_mask:0xf bank_mask:0xf
    v_and_b32_dpp v41, v57, v17 row_newbcast:8 row_mask:0xf bank_mask:0xf
    v_and_b32_dpp v42, v57, v18 row_newbcast:8 row_mask:0xf bank_mask:0xf
    v_and_b32_dpp v43, v57, v19 row_newbcast:8 row_mask:0xf bank_mask:0xf
    s_waitcnt vmcnt(7)
    s_cmpk_gt_u32 s68, 174
    s_cbranch_scc1 L_d174
    s_waitcnt vmcnt(4)
L_d174:
    buffer_load_dwordx4 v[168:171], v3, s[40:43], s44 offen offset:2048 nt
    v_mfma_f32_16x16x32_bf16 v[20:23], v[40:43], v[136:139], v[20:23]
    v_and_b32_dpp v44, v57, v16 row_newbcast:12 row_mask:0xf bank_mask:0xf
    v_and_b32_dpp v45, v57, v17 row_newbcast:12 row_mask:0xf bank_mask:0xf
    v_and_b32_dpp v46, v57, v18 row_newbcast:12 row_mask:0xf bank_mask:0xf
    v_and_b32_dpp v47, v57, v19 row_newbcast:12 row_mask:0xf bank_mask:0xf
    s_waitcnt vmcnt(7)
    s_cmpk_gt_u32 s68, 175
    s_cbranch_scc1 L_d175
    s_waitcnt vmcnt(4)
L_d175:
    buffer_load_dwordx4 v[172:175], v3, s[40:43], s44 offen offset:3072 nt
    v_mfma_f32_16x16x32_bf16 v[20:23], v[44:47], v[140:143], v[20:23]
    v_and_b32_dpp v32, v58, v16 row_newbcast:0 row_mask:0xf bank_mask:0xf
    v_and_b32_dpp v33, v58, v17 row_newbcast:0 row_mask:0xf bank_mask:0xf
    v_and_b32_dpp v34, v58, v18 row_newbcast:0 row_mask:0xf bank_mask:0xf
    v_and_b32_dpp v35, v58, v19 row_newbcast:0 row_mask:0xf bank_mask:0xf
    s_waitcnt vmcnt(7)
    s_cmpk_gt_u32 s68, 176
    s_cbranch_scc1 L_d176
    s_waitcnt vmcnt(4)
L_d176:
    s_mov_b32 s44, 393216
    buffer_load_dwordx4 v[176:179], v3, s[40:43], s44 offen offset:0 nt
    v_mfma_f32_16x16x32_bf16 v[20:23], v[32:35], v[144:147], v[20:23]
    v_and_b32_dpp v36, v58, v16 row_newbcast:4 row_mask:0xf bank_mask:0xf
    v_and_b32_dpp v37, v58, v17 row_newbcast:4 row_mask:0xf bank_mask:0xf
    v_and_b32_dpp v38, v58, v18 row_newbcast:4 row_mask:0xf bank_mask:0xf
    v_and_b32_dpp v39, v58, v19 row_newbcast:4 row_mask:0xf bank_mask:0xf
    s_waitcnt vmcnt(7)
    s_cmpk_gt_u32 s68, 177
    s_cbranch_scc1 L_d177
    s_waitcnt vmcnt(4)
L_d177:
    buffer_load_dwordx4 v[180:183], v3, s[40:43], s44 offen offset:1024 nt
    v_mfma_f32_16x16x32_bf16 v[20:23], v[36:39], v[148:151], v[20:23]
    v_and_b32_dpp v40, v58, v16 row_newbcast:8 row_mask:0xf bank_mask:0xf
    v_and_b32_dpp v41, v58, v17 row_newbcast:8 row_mask:0xf bank_mask:0xf
    v_and_b32_dpp v42, v58, v18 row_newbcast:8 row_mask:0xf bank_mask:0xf
    v_and_b32_dpp v43, v58, v19 row_newbcast:8 row_mask:0xf bank_mask:0xf
    s_waitcnt vmcnt(7)
    s_cmpk_gt_u32 s68, 178
    s_cbranch_scc1 L_d178
    s_waitcnt vmcnt(4)
L_d178:
    buffer_load_dwordx4 v[184:187], v3, s[40:43], s44 offen offset:2048 nt
    v_mfma_f32_16x16x32_bf16 v[20:23], v[40:43], v[152:155], v[20:23]
    v_and_b32_dpp v44, v58, v16 row_newbcast:12 row_mask:0xf bank_mask:0xf
    v_and_b32_dpp v45, v58, v17 row_newbcast:12 row_mask:0xf bank_mask:0xf
    v_and_b32_dpp v46, v58, v18 row_newbcast:12 row_mask:0xf bank_mask:0xf
    v_and_b32_dpp v47, v58, v19 row_newbcast:12 row_mask:0xf bank_mask:0xf
    s_waitcnt vmcnt(7)
    s_cmpk_gt_u32 s68, 179
    s_cbranch_scc1 L_d179
    s_waitcnt vmcnt(4)
L_d179:
    buffer_load_dwordx4 v[188:191], v3, s[40:43], s44 offen offset:3072 nt
    v_mfma_f32_16x16x32_bf16 v[20:23], v[44:47], v[156:159], v[20:23]
    v_and_b32_dpp v32, v59, v16 row_newbcast:0 row_mask:0xf bank_mask:0xf
    v_and_b32_dpp v33, v59, v17 row_newbcast:0 row_mask:0xf bank_mask:0xf
    v_and_b32_dpp v34, v59, v18 row_newbcast:0 row_mask:0xf bank_mask:0xf
    v_and_b32_dpp v35, v59, v19 row_newbcast:0 row_mask:0xf bank_mask:0xf
    s_waitcnt vmcnt(7)
    s_cmpk_gt_u32 s68, 180
    s_cbranch_scc1 L_d180
    s_waitcnt vmcnt(4)
L_d180:
    s_mov_b32 s44, 409600
    buffer_load_dwordx4 v[192:195], v3, s[40:43], s44 offen offset:0 nt
    v_mfma_f32_16x16x32_bf16 v[20:23], v[32:35], v[160:163], v[20:23]
    v_and_b32_dpp v36, v59, v16 row_newbcast:4 row_mask:0xf bank_mask:0xf
    v_and_b32_dpp v37, v59, v17 row_newbcast:4 row_mask:0xf bank_mask:0xf
    v_and_b32_dpp v38, v59, v18 row_newbcast:4 row_mask:0xf bank_mask:0xf
    v_and_b32_dpp v39, v59, v19 row_newbcast:4 row_mask:0xf bank_mask:0xf
    s_waitcnt vmcnt(7)
    s_cmpk_gt_u32 s68, 181
    s_cbranch_scc1 L_d181
    s_waitcnt vmcnt(4)
L_d181:
    buffer_load_dwordx4 v[196:199], v3, s[40:43], s44 offen offset:1024 nt
    v_mfma_f32_16x16x32_bf16 v[20:23], v[36:39], v[164:167], v[20:23]
    v_and_b32_dpp v40, v59, v16 row_newbcast:8 row_mask:0xf bank_mask:0xf
    v_and_b32_dpp v41, v59, v17 row_newbcast:8 row_mask:0xf bank_mask:0xf
    v_and_b32_dpp v42, v59, v18 row_newbcast:8 row_mask:0xf bank_mask:0xf
    v_and_b32_dpp v43, v59, v19 row_newbcast:8 row_mask:0xf bank_mask:0xf
    s_waitcnt vmcnt(7)
    s_cmpk_gt_u32 s68, 182
    s_cbranch_scc1 L_d182
    s_waitcnt vmcnt(4)
L_d182:
    buffer_load_dwordx4 v[200:203], v3, s[40:43], s44 offen offset:2048 nt
    v_mfma_f32_16x16x32_bf16 v[20:23], v[40:43], v[168:171], v[20:23]
    v_and_b32_dpp v44, v59, v16 row_newbcast:12 row_mask:0xf bank_mask:0xf
    v_and_b32_dpp v45, v59, v17 row_newbcast:12 row_mask:0xf bank_mask:0xf
    v_and_b32_dpp v46, v59, v18 row_newbcast:12 row_mask:0xf bank_mask:0xf
    v_and_b32_dpp v47, v59, v19 row_newbcast:12 row_mask:0xf bank_mask:0xf
    s_waitcnt vmcnt(7)
    s_cmpk_gt_u32 s68, 183
    s_cbranch_scc1 L_d183
    s_waitcnt vmcnt(4)
L_d183:
    buffer_load_dwordx4 v[204:207], v3, s[40:43], s44 offen offset:3072 nt
    v_mfma_f32_16x16x32_bf16 v[20:23], v[44:47], v[172:175], v[20:23]
    v_and_b32_dpp v32, v60, v16 row_newbcast:0 row_mask:0xf bank_mask:0xf
    v_and_b32_dpp v33, v60, v17 row_newbcast:0 row_mask:0xf bank_mask:0xf
    v_and_b32_dpp v34, v60, v18 row_newbcast:0 row_mask:0xf bank_mask:0xf
    v_and_b32_dpp v35, v60, v19 row_newbcast:0 row_mask:0xf bank_mask:0xf
    s_waitcnt vmcnt(7)
    s_cmpk_gt_u32 s68, 184
    s_cbranch_scc1 L_d184
    s_waitcnt vmcnt(4)
L_d184:
    s_mov_b32 s44, 458752
    buffer_load_dwordx4 v[208:211], v3, s[40:43], s44 offen offset:0 nt
    v_mfma_f32_16x16x32_bf16 v[20:23], v[32:35], v[176:179], v[20:23]
    v_and_b32_dpp v36, v60, v16 row_newbcast:4 row_mask:0xf bank_mask:0xf
    v_and_b32_dpp v37, v60, v17 row_newbcast:4 row_mask:0xf bank_mask:0xf
    v_and_b32_dpp v38, v60, v18 row_newbcast:4 row_mask:0xf bank_mask:0xf
    v_and_b32_dpp v39, v60, v19 row_newbcast:4 row_mask:0xf bank_mask:0xf
    s_waitcnt vmcnt(7)
    s_cmpk_gt_u32 s68, 185
    s_cbranch_scc1 L_d185
    s_waitcnt vmcnt(4)
L_d185:
    buffer_load_dwordx4 v[212:215], v3, s[40:43], s44 offen offset:1024 nt
    v_mfma_f32_16x16x32_bf16 v[20:23], v[36:39], v[180:183], v[20:23]
    v_and_b32_dpp v40, v60, v16 row_newbcast:8 row_mask:0xf bank_mask:0xf
    v_and_b32_dpp v41, v60, v17 row_newbcast:8 row_mask:0xf bank_mask:0xf
    v_and_b32_dpp v42, v60, v18 row_newbcast:8 row_mask:0xf bank_mask:0xf
    v_and_b32_dpp v43, v60, v19 row_newbcast:8 row_mask:0xf bank_mask:0xf
    s_waitcnt vmcnt(7)
    s_cmpk_gt_u32 s68, 186
    s_cbranch_scc1 L_d186
    s_waitcnt vmcnt(4)
L_d186:
    buffer_load_dwordx4 v[216:219], v3, s[40:43], s44 offen offset:2048 nt
    v_mfma_f32_16x16x32_bf16 v[20:23], v[40:43], v[184:187], v[20:23]
    v_and_b32_dpp v44, v60, v16 row_newbcast:12 row_mask:0xf bank_mask:0xf
    v_and_b32_dpp v45, v60, v17 row_newbcast:12 row_mask:0xf bank_mask:0xf
    v_and_b32_dpp v46, v60, v18 row_newbcast:12 row_mask:0xf bank_mask:0xf
    v_and_b32_dpp v47, v60, v19 row_newbcast:12 row_mask:0xf bank_mask:0xf
    s_waitcnt vmcnt(7)
    s_cmpk_gt_u32 s68, 187
    s_cbranch_scc1 L_d187
    s_waitcnt vmcnt(4)
L_d187:
    buffer_load_dwordx4 v[220:223], v3, s[40:43], s44 offen offset:3072 nt
    v_mfma_f32_16x16x32_bf16 v[20:23], v[44:47], v[188:191], v[20:23]
    v_and_b32_dpp v32, v61, v16 row_newbcast:0 row_mask:0xf bank_mask:0xf
    v_and_b32_dpp v33, v61, v17 row_newbcast:0 row_mask:0xf bank_mask:0xf
    v_and_b32_dpp v34, v61, v18 row_newbcast:0 row_mask:0xf bank_mask:0xf
    v_and_b32_dpp v35, v61, v19 row_newbcast:0 row_mask:0xf bank_mask:0xf
    s_waitcnt vmcnt(7)
    s_cmpk_gt_u32 s68, 188
    s_cbranch_scc1 L_d188
    s_waitcnt vmcnt(4)
L_d188:
    s_mov_b32 s44, 475136
    buffer_load_dwordx4 v[224:227], v3, s[40:43], s44 offen offset:0 nt
    v_mfma_f32_16x16x32_bf16 v[20:23], v[32:35], v[192:195], v[20:23]
    v_and_b32_dpp v36, v61, v16 row_newbcast:4 row_mask:0xf bank_mask:0xf
    v_and_b32_dpp v37, v61, v17 row_newbcast:4 row_mask:0xf bank_mask:0xf
    v_and_b32_dpp v38, v61, v18 row_newbcast:4 row_mask:0xf bank_mask:0xf
    v_and_b32_dpp v39, v61, v19 row_newbcast:4 row_mask:0xf bank_mask:0xf
    s_waitcnt vmcnt(7)
    s_cmpk_gt_u32 s68, 189
    s_cbranch_scc1 L_d189
    s_waitcnt vmcnt(4)
L_d189:
    buffer_load_dwordx4 v[228:231], v3, s[40:43], s44 offen offset:1024 nt
    v_mfma_f32_16x16x32_bf16 v[20:23], v[36:39], v[196:199], v[20:23]
    v_and_b32_dpp v40, v61, v16 row_newbcast:8 row_mask:0xf bank_mask:0xf
    v_and_b32_dpp v41, v61, v17 row_newbcast:8 row_mask:0xf bank_mask:0xf
    v_and_b32_dpp v42, v61, v18 row_newbcast:8 row_mask:0xf bank_mask:0xf
    v_and_b32_dpp v43, v61, v19 row_newbcast:8 row_mask:0xf bank_mask:0xf
    s_waitcnt vmcnt(7)
    s_cmpk_gt_u32 s68, 190
    s_cbranch_scc1 L_d190
    s_waitcnt vmcnt(4)
L_d190:
    buffer_load_dwordx4 v[232:235], v3, s[40:43], s44 offen offset:2048 nt
    v_mfma_f32_16x16x32_bf16 v[20:23], v[40:43], v[200:203], v[20:23]
    v_and_b32_dpp v44, v61, v16 row_newbcast:12 row_mask:0xf bank_mask:0xf
    v_and_b32_dpp v45, v61, v17 row_newbcast:12 row_mask:0xf bank_mask:0xf
    v_and_b32_dpp v46, v61, v18 row_newbcast:12 row_mask:0xf bank_mask:0xf
    v_and_b32_dpp v47, v61, v19 row_newbcast:12 row_mask:0xf bank_mask:0xf
    s_waitcnt vmcnt(7)
    s_cmpk_gt_u32 s68, 191
    s_cbranch_scc1 L_d191
    s_waitcnt vmcnt(4)
L_d191:
    buffer_load_dwordx4 v[236:239], v3, s[40:43], s44 offen offset:3072 nt
    v_mfma_f32_16x16x32_bf16 v[20:23], v[44:47], v[204:207], v[20:23]
    v_and_b32_dpp v32, v62, v16 row_newbcast:0 row_mask:0xf bank_mask:0xf
    v_and_b32_dpp v33, v62, v17 row_newbcast:0 row_mask:0xf bank_mask:0xf
    v_and_b32_dpp v34, v62, v18 row_newbcast:0 row_mask:0xf bank_mask:0xf
    v_and_b32_dpp v35, v62, v19 row_newbcast:0 row_mask:0xf bank_mask:0xf
    s_waitcnt vmcnt(7)
    s_cmpk_gt_u32 s68, 192
    s_cbranch_scc1 L_d192
    s_waitcnt vmcnt(4)
L_d192:
    s_mov_b32 s44, 524288
    buffer_load_dwordx4 v[240:243], v3, s[40:43], s44 offen offset:0 nt
    v_mfma_f32_16x16x32_bf16 v[20:23], v[32:35], v[208:211], v[20:23]
    v_and_b32_dpp v36, v62, v16 row_newbcast:4 row_mask:0xf bank_mask:0xf
    v_and_b32_dpp v37, v62, v17 row_newbcast:4 row_mask:0xf bank_mask:0xf
    v_and_b32_dpp v38, v62, v18 row_newbcast:4 row_mask:0xf bank_mask:0xf
    v_and_b32_dpp v39, v62, v19 row_newbcast:4 row_mask:0xf bank_mask:0xf
    s_waitcnt vmcnt(7)
    s_cmpk_gt_u32 s68, 193
    s_cbranch_scc1 L_d193
    s_waitcnt vmcnt(4)
L_d193:
    buffer_load_dwordx4 v[244:247], v3, s[40:43], s44 offen offset:1024 nt
    v_mfma_f32_16x16x32_bf16 v[20:23], v[36:39], v[212:215], v[20:23]
    v_and_b32_dpp v40, v62, v16 row_newbcast:8 row_mask:0xf bank_mask:0xf
    v_and_b32_dpp v41, v62, v17 row_newbcast:8 row_mask:0xf bank_mask:0xf
    v_and_b32_dpp v42, v62, v18 row_newbcast:8 row_mask:0xf bank_mask:0xf
    v_and_b32_dpp v43, v62, v19 row_newbcast:8 row_mask:0xf bank_mask:0xf
    s_waitcnt vmcnt(7)
    s_cmpk_gt_u32 s68, 194
    s_cbranch_scc1 L_d194
    s_waitcnt vmcnt(4)
L_d194:
    buffer_load_dwordx4 v[248:251], v3, s[40:43], s44 offen offset:2048 nt
    v_mfma_f32_16x16x32_bf16 v[20:23], v[40:43], v[216:219], v[20:23]
    v_and_b32_dpp v44, v62, v16 row_newbcast:12 row_mask:0xf bank_mask:0xf
    v_and_b32_dpp v45, v62, v17 row_newbcast:12 row_mask:0xf bank_mask:0xf
    v_and_b32_dpp v46, v62, v18 row_newbcast:12 row_mask:0xf bank_mask:0xf
    v_and_b32_dpp v47, v62, v19 row_newbcast:12 row_mask:0xf bank_mask:0xf
    s_waitcnt vmcnt(7)
    s_cmpk_gt_u32 s68, 195
    s_cbranch_scc1 L_d195
    s_waitcnt vmcnt(4)
L_d195:
    buffer_load_dwordx4 v[252:255], v3, s[40:43], s44 offen offset:3072 nt
    v_mfma_f32_16x16x32_bf16 v[20:23], v[44:47], v[220:223], v[20:23]
    v_and_b32_dpp v32, v63, v16 row_newbcast:0 row_mask:0xf bank_mask:0xf
    v_and_b32_dpp v33, v63, v17 row_newbcast:0 row_mask:0xf bank_mask:0xf
    v_and_b32_dpp v34, v63, v18 row_newbcast:0 row_mask:0xf bank_mask:0xf
    v_and_b32_dpp v35, v63, v19 row_newbcast:0 row_mask:0xf bank_mask:0xf
    s_waitcnt vmcnt(7)
    s_cmpk_gt_u32 s68, 196
    s_cbranch_scc1 L_d196
    s_waitcnt vmcnt(4)
L_d196:
    s_mov_b32 s44, 540672
    buffer_load_dwordx4 v[80:83], v3, s[40:43], s44 offen offset:0 nt
    buffer_load_dword v26, v13, s[56:59], 0 offen offset:128 sc1
    v_mfma_f32_16x16x32_bf16 v[20:23], v[32:35], v[224:227], v[20:23]
    v_and_b32_dpp v36, v63, v16 row_newbcast:4 row_mask:0xf bank_mask:0xf
    v_and_b32_dpp v37, v63, v17 row_newbcast:4 row_mask:0xf bank_mask:0xf
    v_and_b32_dpp v38, v63, v18 row_newbcast:4 row_mask:0xf bank_mask:0xf
    v_and_b32_dpp v39, v63, v19 row_newbcast:4 row_mask:0xf bank_mask:0xf
    s_waitcnt vmcnt(8)
    s_cmpk_gt_u32 s68, 197
    s_cbranch_scc1 L_d197
    s_waitcnt vmcnt(5)
L_d197:
    buffer_load_dwordx4 v[84:87], v3, s[40:43], s44 offen offset:1024 nt
    v_mfma_f32_16x16x32_bf16 v[20:23], v[36:39], v[228:231], v[20:23]
    v_and_b32_dpp v40, v63, v16 row_newbcast:8 row_mask:0xf bank_mask:0xf
    v_and_b32_dpp v41, v63, v17 row_newbcast:8 row_mask:0xf bank_mask:0xf
    v_and_b32_dpp v42, v63, v18 row_newbcast:8 row_mask:0xf bank_mask:0xf
    v_and_b32_dpp v43, v63, v19 row_newbcast:8 row_mask:0xf bank_mask:0xf
    s_waitcnt vmcnt(8)
    s_cmpk_gt_u32 s68, 198
    s_cbranch_scc1 L_d198
    s_waitcnt vmcnt(5)
L_d198:
    buffer_load_dwordx4 v[88:91], v3, s[40:43], s44 offen offset:2048 nt
    buffer_load_dword v27, v13, s[56:59], 0 offen offset:128 sc1
    v_mfma_f32_16x16x32_bf16 v[20:23], v[40:43], v[232:235], v[20:23]
    v_and_b32_dpp v44, v63, v16 row_newbcast:12 row_mask:0xf bank_mask:0xf
    v_and_b32_dpp v45, v63, v17 row_newbcast:12 row_mask:0xf bank_mask:0xf
    v_and_b32_dpp v46, v63, v18 row_newbcast:12 row_mask:0xf bank_mask:0xf
    v_and_b32_dpp v47, v63, v19 row_newbcast:12 row_mask:0xf bank_mask:0xf
    s_waitcnt vmcnt(9)
    s_cmpk_gt_u32 s68, 199
    s_cbranch_scc1 L_d199
    s_waitcnt vmcnt(6)
L_d199:
    buffer_load_dwordx4 v[92:95], v3, s[40:43], s44 offen offset:3072 nt
    v_mfma_f32_16x16x32_bf16 v[20:23], v[44:47], v[236:239], v[20:23]
    v_and_b32_dpp v32, v64, v16 row_newbcast:0 row_mask:0xf bank_mask:0xf
    v_and_b32_dpp v33, v64, v17 row_newbcast:0 row_mask:0xf bank_mask:0xf
    v_and_b32_dpp v34, v64, v18 row_newbcast:0 row_mask:0xf bank_mask:0xf
    v_and_b32_dpp v35, v64, v19 row_newbcast:0 row_mask:0xf bank_mask:0xf
    s_waitcnt vmcnt(9)
    s_cmpk_gt_u32 s68, 200
    s_cbranch_scc1 L_d200
    s_waitcnt vmcnt(6)
L_d200:
    s_mov_b32 s44, 589824
    buffer_load_dwordx4 v[96:99], v3, s[40:43], s44 offen offset:0 nt
    buffer_load_dword v28, v13, s[56:59], 0 offen offset:128 sc1
    v_mfma_f32_16x16x32_bf16 v[20:23], v[32:35], v[240:243], v[20:23]
    v_and_b32_dpp v36, v64, v16 row_newbcast:4 row_mask:0xf bank_mask:0xf
    v_and_b32_dpp v37, v64, v17 row_newbcast:4 row_mask:0xf bank_mask:0xf
    v_and_b32_dpp v38, v64, v18 row_newbcast:4 row_mask:0xf bank_mask:0xf
    v_and_b32_dpp v39, v64, v19 row_newbcast:4 row_mask:0xf bank_mask:0xf
    s_waitcnt vmcnt(10)
    s_cmpk_gt_u32 s68, 201
    s_cbranch_scc1 L_d201
    s_waitcnt vmcnt(7)
L_d201:
    buffer_load_dwordx4 v[100:103], v3, s[40:43], s44 offen offset:1024 nt
    v_mfma_f32_16x16x32_bf16 v[20:23], v[36:39], v[244:247], v[20:23]
    v_and_b32_dpp v40, v64, v16 row_newbcast:8 row_mask:0xf bank_mask:0xf
    v_and_b32_dpp v41, v64, v17 row_newbcast:8 row_mask:0xf bank_mask:0xf
    v_and_b32_dpp v42, v64, v18 row_newbcast:8 row_mask:0xf bank_mask:0xf
    v_and_b32_dpp v43, v64, v19 row_newbcast:8 row_mask:0xf bank_mask:0xf
    s_waitcnt vmcnt(10)
    s_cmpk_gt_u32 s68, 202
    s_cbranch_scc1 L_d202
    s_waitcnt vmcnt(6)
L_d202:
    buffer_load_dwordx4 v[104:107], v3, s[40:43], s44 offen offset:2048 nt
    buffer_load_dword v29, v13, s[56:59], 0 offen offset:128 sc1
    v_mfma_f32_16x16x32_bf16 v[20:23], v[40:43], v[248:251], v[20:23]
    v_and_b32_dpp v44, v64, v16 row_newbcast:12 row_mask:0xf bank_mask:0xf
    v_and_b32_dpp v45, v64, v17 row_newbcast:12 row_mask:0xf bank_mask:0xf
    v_and_b32_dpp v46, v64, v18 row_newbcast:12 row_mask:0xf bank_mask:0xf
    v_and_b32_dpp v47, v64, v19 row_newbcast:12 row_mask:0xf bank_mask:0xf
    s_waitcnt vmcnt(11)
    s_cmpk_gt_u32 s68, 203
    s_cbranch_scc1 L_d203
    s_waitcnt vmcnt(7)
L_d203:
    buffer_load_dwordx4 v[108:111], v3, s[40:43], s44 offen offset:3072 nt
    v_mfma_f32_16x16x32_bf16 v[20:23], v[44:47], v[252:255], v[20:23]
    v_and_b32_dpp v32, v65, v16 row_newbcast:0 row_mask:0xf bank_mask:0xf
    v_and_b32_dpp v33, v65, v17 row_newbcast:0 row_mask:0xf bank_mask:0xf
    v_and_b32_dpp v34, v65, v18 row_newbcast:0 row_mask:0xf bank_mask:0xf
    v_and_b32_dpp v35, v65, v19 row_newbcast:0 row_mask:0xf bank_mask:0xf
    s_waitcnt vmcnt(11)
    s_cmpk_gt_u32 s68, 204
    s_cbranch_scc1 L_d204
    s_waitcnt vmcnt(6)
L_d204:
    s_mov_b32 s44, 606208
    buffer_load_dwordx4 v[112:115], v3, s[40:43], s44 offen offset:0 nt
    s_mov_b64 exec, 1
    buffer_store_dword v15, off, s[52:55], s71 offset:32 sc1
    s_mov_b64 exec, -1
    buffer_load_dword v30, v13, s[56:59], 0 offen offset:128 sc1
    v_mfma_f32_16x16x32_bf16 v[20:23], v[32:35], v[80:83], v[20:23]
    v_and_b32_dpp v36, v65, v16 row_newbcast:4 row_mask:0xf bank_mask:0xf
    v_and_b32_dpp v37, v65, v17 row_newbcast:4 row_mask:0xf bank_mask:0xf
    v_and_b32_dpp v38, v65, v18 row_newbcast:4 row_mask:0xf bank_mask:0xf
    v_and_b32_dpp v39, v65, v19 row_newbcast:4 row_mask:0xf bank_mask:0xf
    s_waitcnt vmcnt(12)
    v_cmp_eq_u32 vcc, v14, v26
    s_nop 0
    s_bcnt1_i32_b32 s69, vcc_lo
    s_cmp_ge_u32 s69, 16
    s_cselect_b32 s69, 252, 0
    s_max_u32 s68, s68, s69
    s_cmpk_gt_u32 s68, 205
    s_cbranch_scc1 L_d205
    s_waitcnt vmcnt(8)
L_d205:
    buffer_load_dwordx4 v[116:119], v3, s[40:43], s44 offen offset:1024 nt
    v_mfma_f32_16x16x32_bf16 v[20:23], v[36:39], v[84:87], v[20:23]
    v_and_b32_dpp v40, v65, v16 row_newbcast:8 row_mask:0xf bank_mask:0xf
    v_and_b32_dpp v41, v65, v17 row_newbcast:8 row_mask:0xf bank_mask:0xf
    v_and_b32_dpp v42, v65, v18 row_newbcast:8 row_mask:0xf bank_mask:0xf
    v_and_b32_dpp v43, v65, v19 row_newbcast:8 row_mask:0xf bank_mask:0xf
    s_waitcnt vmcnt(12)
    s_cmpk_gt_u32 s68, 206
    s_cbranch_scc1 L_d206
    s_waitcnt vmcnt(7)
L_d206:
    buffer_load_dwordx4 v[120:123], v3, s[40:43], s44 offen offset:2048 nt
    buffer_load_dword v31, v13, s[56:59], 0 offen offset:128 sc1
    v_mfma_f32_16x16x32_bf16 v[20:23], v[40:43], v[88:91], v[20:23]
    v_and_b32_dpp v44, v65, v16 row_newbcast:12 row_mask:0xf bank_mask:0xf
    v_and_b32_dpp v45, v65, v17 row_newbcast:12 row_mask:0xf bank_mask:0xf
    v_and_b32_dpp v46, v65, v18 row_newbcast:12 row_mask:0xf bank_mask:0xf
    v_and_b32_dpp v47, v65, v19 row_newbcast:12 row_mask:0xf bank_mask:0xf
    s_waitcnt vmcnt(12)
    v_cmp_eq_u32 vcc, v14, v27
    s_nop 0
    s_bcnt1_i32_b32 s69, vcc_lo
    s_cmp_ge_u32 s69, 16
    s_cselect_b32 s69, 246, 0
    s_max_u32 s68, s68, s69
    s_cmpk_gt_u32 s68, 207
    s_cbranch_scc1 L_d207
    s_waitcnt vmcnt(8)
L_d207:
    buffer_load_dwordx4 v[124:127], v3, s[40:43], s44 offen offset:3072 nt
    v_mfma_f32_16x16x32_bf16 v[20:23], v[44:47], v[92:95], v[20:23]
    v_and_b32_dpp v32, v66, v16 row_newbcast:0 row_mask:0xf bank_mask:0xf
    v_and_b32_dpp v33, v66, v17 row_newbcast:0 row_mask:0xf bank_mask:0xf
    v_and_b32_dpp v34, v66, v18 row_newbcast:0 row_mask:0xf bank_mask:0xf
    v_and_b32_dpp v35, v66, v19 row_newbcast:0 row_mask:0xf bank_mask:0xf
    s_waitcnt vmcnt(12)
    s_cmpk_gt_u32 s68, 208
    s_cbranch_scc1 L_d208
    s_waitcnt vmcnt(7)
L_d208:
    s_mov_b32 s44, 655360
    buffer_load_dwordx4 v[128:131], v3, s[40:43], s44 offen offset:0 nt
    v_mfma_f32_16x16x32_bf16 v[20:23], v[32:35], v[96:99], v[20:23]
    v_and_b32_dpp v36, v66, v16 row_newbcast:4 row_mask:0xf bank_mask:0xf
    v_and_b32_dpp v37, v66, v17 row_newbcast:4 row_mask:0xf bank_mask:0xf
    v_and_b32_dpp v38, v66, v18 row_newbcast:4 row_mask:0xf bank_mask:0xf
    v_and_b32_dpp v39, v66, v19 row_newbcast:4 row_mask:0xf bank_mask:0xf
    s_waitcnt vmcnt(11)
    v_cmp_eq_u32 vcc, v14, v28
    s_nop 0
    s_bcnt1_i32_b32 s69, vcc_lo
    s_cmp_ge_u32 s69, 16
    s_cselect_b32 s69, 240, 0
    s_max_u32 s68, s68, s69
    s_cmpk_gt_u32 s68, 209
    s_cbranch_scc1 L_d209
    s_waitcnt vmcnt(7)
L_d209:
    buffer_load_dwordx4 v[132:135], v3, s[40:43], s44 offen offset:1024 nt
    v_mfma_f32_16x16x32_bf16 v[20:23], v[36:39], v[100:103], v[20:23]
    v_and_b32_dpp v40, v66, v16 row_newbcast:8 row_mask:0xf bank_mask:0xf
    v_and_b32_dpp v41, v66, v17 row_newbcast:8 row_mask:0xf bank_mask:0xf
    v_and_b32_dpp v42, v66, v18 row_newbcast:8 row_mask:0xf bank_mask:0xf
    v_and_b32_dpp v43, v66, v19 row_newbcast:8 row_mask:0xf bank_mask:0xf
    s_waitcnt vmcnt(11)
    s_cmpk_gt_u32 s68, 210
    s_cbranch_scc1 L_d210
    s_waitcnt vmcnt(5)
L_d210:
    buffer_load_dwordx4 v[136:139], v3, s[40:43], s44 offen offset:2048 nt
    v_mfma_f32_16x16x32_bf16 v[20:23], v[40:43], v[104:107], v[20:23]
    v_and_b32_dpp v44, v66, v16 row_newbcast:12 row_mask:0xf bank_mask:0xf
    v_and_b32_dpp v45, v66, v17 row_newbcast:12 row_mask:0xf bank_mask:0xf
    v_and_b32_dpp v46, v66, v18 row_newbcast:12 row_mask:0xf bank_mask:0xf
    v_and_b32_dpp v47, v66, v19 row_newbcast:12 row_mask:0xf bank_mask:0xf
    s_waitcnt vmcnt(10)
    v_cmp_eq_u32 vcc, v14, v29
    s_nop 0
    s_bcnt1_i32_b32 s69, vcc_lo
    s_cmp_ge_u32 s69, 16
    s_cselect_b32 s69, 234, 0
    s_max_u32 s68, s68, s69
    s_cmpk_gt_u32 s68, 211
    s_cbranch_scc1 L_d211
    s_waitcnt vmcnt(5)
L_d211:
    buffer_load_dwordx4 v[140:143], v3, s[40:43], s44 offen offset:3072 nt
    v_mfma_f32_16x16x32_bf16 v[20:23], v[44:47], v[108:111], v[20:23]
    v_and_b32_dpp v32, v67, v16 row_newbcast:0 row_mask:0xf bank_mask:0xf
    v_and_b32_dpp v33, v67, v17 row_newbcast:0 row_mask:0xf bank_mask:0xf
    v_and_b32_dpp v34, v67, v18 row_newbcast:0 row_mask:0xf bank_mask:0xf
    v_and_b32_dpp v35, v67, v19 row_newbcast:0 row_mask:0xf bank_mask:0xf
    s_waitcnt vmcnt(10)
    s_cmpk_gt_u32 s68, 212
    s_cbranch_scc1 L_d212
    s_waitcnt vmcnt(4)
L_d212:
    s_mov_b32 s44, 671744
    buffer_load_dwordx4 v[144:147], v3, s[40:43], s44 offen offset:0 nt
    v_mfma_f32_16x16x32_bf16 v[20:23], v[32:35], v[112:115], v[20:23]
    v_and_b32_dpp v36, v67, v16 row_newbcast:4 row_mask:0xf bank_mask:0xf
    v_and_b32_dpp v37, v67, v17 row_newbcast:4 row_mask:0xf bank_mask:0xf
    v_and_b32_dpp v38, v67, v18 row_newbcast:4 row_mask:0xf bank_mask:0xf
    v_and_b32_dpp v39, v67, v19 row_newbcast:4 row_mask:0xf bank_mask:0xf
    s_waitcnt vmcnt(8)
    v_cmp_eq_u32 vcc, v14, v30
    s_nop 0
    s_bcnt1_i32_b32 s69, vcc_lo
    s_cmp_ge_u32 s69, 16
    s_cselect_b32 s69, 228, 0
    s_max_u32 s68, s68, s69
    s_cmpk_gt_u32 s68, 213
    s_cbranch_scc1 L_d213
    s_waitcnt vmcnt(4)
L_d213:
    buffer_load_dwordx4 v[148:151], v3, s[40:43], s44 offen offset:1024 nt
    v_mfma_f32_16x16x32_bf16 v[20:23], v[36:39], v[116:119], v[20:23]
    v_and_b32_dpp v40, v67, v16 row_newbcast:8 row_mask:0xf bank_mask:0xf
    v_and_b32_dpp v41, v67, v17 row_newbcast:8 row_mask:0xf bank_mask:0xf
    v_and_b32_dpp v42, v67, v18 row_newbcast:8 row_mask:0xf bank_mask:0xf
    v_and_b32_dpp v43, v67, v19 row_newbcast:8 row_mask:0xf bank_mask:0xf
    s_waitcnt vmcnt(8)
    s_cmpk_gt_u32 s68, 214
    s_cbranch_scc1 L_d214
    s_waitcnt vmcnt(4)
L_d214:
    buffer_load_dwordx4 v[152:155], v3, s[40:43], s44 offen offset:2048 nt
    v_mfma_f32_16x16x32_bf16 v[20:23], v[40:43], v[120:123], v[20:23]
    v_and_b32_dpp v44, v67, v16 row_newbcast:12 row_mask:0xf bank_mask:0xf
    v_and_b32_dpp v45, v67, v17 row_newbcast:12 row_mask:0xf bank_mask:0xf
    v_and_b32_dpp v46, v67, v18 row_newbcast:12 row_mask:0xf bank_mask:0xf
    v_and_b32_dpp v47, v67, v19 row_newbcast:12 row_mask:0xf bank_mask:0xf
    s_waitcnt vmcnt(7)
    v_cmp_eq_u32 vcc, v14, v31
    s_nop 0
    s_bcnt1_i32_b32 s69, vcc_lo
    s_cmp_ge_u32 s69, 16
    s_cselect_b32 s69, 222, 0
    s_max_u32 s68, s68, s69
    s_cmpk_gt_u32 s68, 215
    s_cbranch_scc1 L_d215
    s_waitcnt vmcnt(4)
L_d215:
    buffer_load_dwordx4 v[156:159], v3, s[40:43], s44 offen offset:3072 nt
    v_mfma_f32_16x16x32_bf16 v[20:23], v[44:47], v[124:127], v[20:23]
    v_and_b32_dpp v32, v68, v16 row_newbcast:0 row_mask:0xf bank_mask:0xf
    v_and_b32_dpp v33, v68, v17 row_newbcast:0 row_mask:0xf bank_mask:0xf
    v_and_b32_dpp v34, v68, v18 row_newbcast:0 row_mask:0xf bank_mask:0xf
    v_and_b32_dpp v35, v68, v19 row_newbcast:0 row_mask:0xf bank_mask:0xf
    s_waitcnt vmcnt(7)
    s_cmpk_gt_u32 s68, 216
    s_cbranch_scc1 L_d216
    s_waitcnt vmcnt(4)
L_d216:
    s_mov_b32 s44, 720896
    buffer_load_dwordx4 v[160:163], v3, s[40:43], s44 offen offset:0 nt
    v_mfma_f32_16x16x32_bf16 v[20:23], v[32:35], v[128:131], v[20:23]
    v_and_b32_dpp v36, v68, v16 row_newbcast:4 row_mask:0xf bank_mask:0xf
    v_and_b32_dpp v37, v68, v17 row_newbcast:4 row_mask:0xf bank_mask:0xf
    v_and_b32_dpp v38, v68, v18 row_newbcast:4 row_mask:0xf bank_mask:0xf
    v_and_b32_dpp v39, v68, v19 row_newbcast:4 row_mask:0xf bank_mask:0xf
    s_waitcnt vmcnt(7)
    s_cmpk_gt_u32 s68, 217
    s_cbranch_scc1 L_d217
    s_waitcnt vmcnt(4)
L_d217:
    buffer_load_dwordx4 v[164:167], v3, s[40:43], s44 offen offset:1024 nt
    v_mfma_f32_16x16x32_bf16 v[20:23], v[36:39], v[132:135], v[20:23]
    v_and_b32_dpp v40, v68, v16 row_newbcast:8 row_mask:0xf bank_mask:0xf
    v_and_b32_dpp v41, v68, v17 row_newbcast:8 row_mask:0xf bank_mask:0xf
    v_and_b32_dpp v42, v68, v18 row_newbcast:8 row_mask:0xf bank_mask:0xf
    v_and_b32_dpp v43, v68, v19 row_newbcast:8 row_mask:0xf bank_mask:0xf
    s_waitcnt vmcnt(7)
    s_cmpk_gt_u32 s68, 218
    s_cbranch_scc1 L_d218
    s_waitcnt vmcnt(4)
L_d218:
    buffer_load_dwordx4 v[168:171], v3, s[40:43], s44 offen offset:2048 nt
    v_mfma_f32_16x16x32_bf16 v[20:23], v[40:43], v[136:139], v[20:23]
    v_and_b32_dpp v44, v68, v16 row_newbcast:12 row_mask:0xf bank_mask:0xf
    v_and_b32_dpp v45, v68, v17 row_newbcast:12 row_mask:0xf bank_mask:0xf
    v_and_b32_dpp v46, v68, v18 row_newbcast:12 row_mask:0xf bank_mask:0xf
    v_and_b32_dpp v47, v68, v19 row_newbcast:12 row_mask:0xf bank_mask:0xf
    s_waitcnt vmcnt(7)
    s_cmpk_gt_u32 s68, 219
    s_cbranch_scc1 L_d219
    s_waitcnt vmcnt(4)
L_d219:
    buffer_load_dwordx4 v[172:175], v3, s[40:43], s44 offen offset:3072 nt
    v_mfma_f32_16x16x32_bf16 v[20:23], v[44:47], v[140:143], v[20:23]
    v_and_b32_dpp v32, v69, v16 row_newbcast:0 row_mask:0xf bank_mask:0xf
    v_and_b32_dpp v33, v69, v17 row_newbcast:0 row_mask:0xf bank_mask:0xf
    v_and_b32_dpp v34, v69, v18 row_newbcast:0 row_mask:0xf bank_mask:0xf
    v_and_b32_dpp v35, v69, v19 row_newbcast:0 row_mask:0xf bank_mask:0xf
    s_waitcnt vmcnt(7)
    s_cmpk_gt_u32 s68, 220
    s_cbranch_scc1 L_d220
    s_waitcnt vmcnt(4)
L_d220:
    s_mov_b32 s44, 737280
    buffer_load_dwordx4 v[176:179], v3, s[40:43], s44 offen offset:0 nt
    v_mfma_f32_16x16x32_bf16 v[20:23], v[32:35], v[144:147], v[20:23]
    v_and_b32_dpp v36, v69, v16 row_newbcast:4 row_mask:0xf bank_mask:0xf
    v_and_b32_dpp v37, v69, v17 row_newbcast:4 row_mask:0xf bank_mask:0xf
    v_and_b32_dpp v38, v69, v18 row_newbcast:4 row_mask:0xf bank_mask:0xf
    v_and_b32_dpp v39, v69, v19 row_newbcast:4 row_mask:0xf bank_mask:0xf
    s_waitcnt vmcnt(7)
    s_cmpk_gt_u32 s68, 221
    s_cbranch_scc1 L_d221
    s_waitcnt vmcnt(4)
L_d221:
    buffer_load_dwordx4 v[180:183], v3, s[40:43], s44 offen offset:1024 nt
    v_mfma_f32_16x16x32_bf16 v[20:23], v[36:39], v[148:151], v[20:23]
    v_and_b32_dpp v40, v69, v16 row_newbcast:8 row_mask:0xf bank_mask:0xf
    v_and_b32_dpp v41, v69, v17 row_newbcast:8 row_mask:0xf bank_mask:0xf
    v_and_b32_dpp v42, v69, v18 row_newbcast:8 row_mask:0xf bank_mask:0xf
    v_and_b32_dpp v43, v69, v19 row_newbcast:8 row_mask:0xf bank_mask:0xf
    s_waitcnt vmcnt(7)
    s_cmpk_gt_u32 s68, 222
    s_cbranch_scc1 L_d222
    s_waitcnt vmcnt(4)
L_d222:
    buffer_load_dwordx4 v[184:187], v3, s[40:43], s44 offen offset:2048 nt
    v_mfma_f32_16x16x32_bf16 v[20:23], v[40:43], v[152:155], v[20:23]
    v_and_b32_dpp v44, v69, v16 row_newbcast:12 row_mask:0xf bank_mask:0xf
    v_and_b32_dpp v45, v69, v17 row_newbcast:12 row_mask:0xf bank_mask:0xf
    v_and_b32_dpp v46, v69, v18 row_newbcast:12 row_mask:0xf bank_mask:0xf
    v_and_b32_dpp v47, v69, v19 row_newbcast:12 row_mask:0xf bank_mask:0xf
    s_waitcnt vmcnt(7)
    s_cmpk_gt_u32 s68, 223
    s_cbranch_scc1 L_d223
    s_waitcnt vmcnt(4)
L_d223:
    buffer_load_dwordx4 v[188:191], v3, s[40:43], s44 offen offset:3072 nt
    v_mfma_f32_16x16x32_bf16 v[20:23], v[44:47], v[156:159], v[20:23]
    v_and_b32_dpp v32, v70, v16 row_newbcast:0 row_mask:0xf bank_mask:0xf
    v_and_b32_dpp v33, v70, v17 row_newbcast:0 row_mask:0xf bank_mask:0xf
    v_and_b32_dpp v34, v70, v18 row_newbcast:0 row_mask:0xf bank_mask:0xf
    v_and_b32_dpp v35, v70, v19 row_newbcast:0 row_mask:0xf bank_mask:0xf
    s_waitcnt vmcnt(7)
    s_cmpk_gt_u32 s68, 224
    s_cbranch_scc1 L_d224
    s_waitcnt vmcnt(4)
L_d224:
    s_mov_b32 s44, 786432
    buffer_load_dwordx4 v[192:195], v3, s[40:43], s44 offen offset:0 nt
    v_mfma_f32_16x16x32_bf16 v[20:23], v[32:35], v[160:163], v[20:23]
    v_and_b32_dpp v36, v70, v16 row_newbcast:4 row_mask:0xf bank_mask:0xf
    v_and_b32_dpp v37, v70, v17 row_newbcast:4 row_mask:0xf bank_mask:0xf
    v_and_b32_dpp v38, v70, v18 row_newbcast:4 row_mask:0xf bank_mask:0xf
    v_and_b32_dpp v39, v70, v19 row_newbcast:4 row_mask:0xf bank_mask:0xf
    s_waitcnt vmcnt(7)
    s_cmpk_gt_u32 s68, 225
    s_cbranch_scc1 L_d225
    s_waitcnt vmcnt(4)
L_d225:
    buffer_load_dwordx4 v[196:199], v3, s[40:43], s44 offen offset:1024 nt
    v_mfma_f32_16x16x32_bf16 v[20:23], v[36:39], v[164:167], v[20:23]
    v_and_b32_dpp v40, v70, v16 row_newbcast:8 row_mask:0xf bank_mask:0xf
    v_and_b32_dpp v41, v70, v17 row_newbcast:8 row_mask:0xf bank_mask:0xf
    v_and_b32_dpp v42, v70, v18 row_newbcast:8 row_mask:0xf bank_mask:0xf
    v_and_b32_dpp v43, v70, v19 row_newbcast:8 row_mask:0xf bank_mask:0xf
    s_waitcnt vmcnt(7)
    s_cmpk_gt_u32 s68, 226
    s_cbranch_scc1 L_d226
    s_waitcnt vmcnt(4)
L_d226:
    buffer_load_dwordx4 v[200:203], v3, s[40:43], s44 offen offset:2048 nt
    v_mfma_f32_16x16x32_bf16 v[20:23], v[40:43], v[168:171], v[20:23]
    v_and_b32_dpp v44, v70, v16 row_newbcast:12 row_mask:0xf bank_mask:0xf
    v_and_b32_dpp v45, v70, v17 row_newbcast:12 row_mask:0xf bank_mask:0xf
    v_and_b32_dpp v46, v70, v18 row_newbcast:12 row_mask:0xf bank_mask:0xf
    v_and_b32_dpp v47, v70, v19 row_newbcast:12 row_mask:0xf bank_mask:0xf
    s_waitcnt vmcnt(7)
    s_cmpk_gt_u32 s68, 227
    s_cbranch_scc1 L_d227
    s_waitcnt vmcnt(4)
L_d227:
    buffer_load_dwordx4 v[204:207], v3, s[40:43], s44 offen offset:3072 nt
    v_mfma_f32_16x16x32_bf16 v[20:23], v[44:47], v[172:175], v[20:23]
    v_and_b32_dpp v32, v71, v16 row_newbcast:0 row_mask:0xf bank_mask:0xf
    v_and_b32_dpp v33, v71, v17 row_newbcast:0 row_mask:0xf bank_mask:0xf
    v_and_b32_dpp v34, v71, v18 row_newbcast:0 row_mask:0xf bank_mask:0xf
    v_and_b32_dpp v35, v71, v19 row_newbcast:0 row_mask:0xf bank_mask:0xf
    s_waitcnt vmcnt(7)
    s_cmpk_gt_u32 s68, 228
    s_cbranch_scc1 L_d228
    s_waitcnt vmcnt(4)
L_d228:
    s_mov_b32 s44, 802816
    buffer_load_dwordx4 v[208:211], v3, s[40:43], s44 offen offset:0 nt
    v_mfma_f32_16x16x32_bf16 v[20:23], v[32:35], v[176:179], v[20:23]
    v_and_b32_dpp v36, v71, v16 row_newbcast:4 row_mask:0xf bank_mask:0xf
    v_and_b32_dpp v37, v71, v17 row_newbcast:4 row_mask:0xf bank_mask:0xf
    v_and_b32_dpp v38, v71, v18 row_newbcast:4 row_mask:0xf bank_mask:0xf
    v_and_b32_dpp v39, v71, v19 row_newbcast:4 row_mask:0xf bank_mask:0xf
    s_waitcnt vmcnt(7)
    s_cmpk_gt_u32 s68, 229
    s_cbranch_scc1 L_d229
    s_waitcnt vmcnt(4)
L_d229:
    buffer_load_dwordx4 v[212:215], v3, s[40:43], s44 offen offset:1024 nt
    v_mfma_f32_16x16x32_bf16 v[20:23], v[36:39], v[180:183], v[20:23]
    v_and_b32_dpp v40, v71, v16 row_newbcast:8 row_mask:0xf bank_mask:0xf
    v_and_b32_dpp v41, v71, v17 row_newbcast:8 row_mask:0xf bank_mask:0xf
    v_and_b32_dpp v42, v71, v18 row_newbcast:8 row_mask:0xf bank_mask:0xf
    v_and_b32_dpp v43, v71, v19 row_newbcast:8 row_mask:0xf bank_mask:0xf
    s_waitcnt vmcnt(7)
    s_cmpk_gt_u32 s68, 230
    s_cbranch_scc1 L_d230
    s_waitcnt vmcnt(4)
L_d230:
    buffer_load_dwordx4 v[216:219], v3, s[40:43], s44 offen offset:2048 nt
    v_mfma_f32_16x16x32_bf16 v[20:23], v[40:43], v[184:187], v[20:23]
    v_and_b32_dpp v44, v71, v16 row_newbcast:12 row_mask:0xf bank_mask:0xf
    v_and_b32_dpp v45, v71, v17 row_newbcast:12 row_mask:0xf bank_mask:0xf
    v_and_b32_dpp v46, v71, v18 row_newbcast:12 row_mask:0xf bank_mask:0xf
    v_and_b32_dpp v47, v71, v19 row_newbcast:12 row_mask:0xf bank_mask:0xf
    s_waitcnt vmcnt(7)
    s_cmpk_gt_u32 s68, 231
    s_cbranch_scc1 L_d231
    s_waitcnt vmcnt(4)
L_d231:
    buffer_load_dwordx4 v[220:223], v3, s[40:43], s44 offen offset:3072 nt
    v_mfma_f32_16x16x32_bf16 v[20:23], v[44:47], v[188:191], v[20:23]
    v_and_b32_dpp v32, v72, v16 row_newbcast:0 row_mask:0xf bank_mask:0xf
    v_and_b32_dpp v33, v72, v17 row_newbcast:0 row_mask:0xf bank_mask:0xf
    v_and_b32_dpp v34, v72, v18 row_newbcast:0 row_mask:0xf bank_mask:0xf
    v_and_b32_dpp v35, v72, v19 row_newbcast:0 row_mask:0xf bank_mask:0xf
    s_waitcnt vmcnt(7)
    s_cmpk_gt_u32 s68, 232
    s_cbranch_scc1 L_d232
    s_waitcnt vmcnt(4)
L_d232:
    s_mov_b32 s44, 851968
    buffer_load_dwordx4 v[224:227], v3, s[40:43], s44 offen offset:0 nt
    v_mfma_f32_16x16x32_bf16 v[20:23], v[32:35], v[192:195], v[20:23]
    v_and_b32_dpp v36, v72, v16 row_newbcast:4 row_mask:0xf bank_mask:0xf
    v_and_b32_dpp v37, v72, v17 row_newbcast:4 row_mask:0xf bank_mask:0xf
    v_and_b32_dpp v38, v72, v18 row_newbcast:4 row_mask:0xf bank_mask:0xf
    v_and_b32_dpp v39, v72, v19 row_newbcast:4 row_mask:0xf bank_mask:0xf
    s_waitcnt vmcnt(7)
    s_cmpk_gt_u32 s68, 233
    s_cbranch_scc1 L_d233
    s_waitcnt vmcnt(4)
L_d233:
    buffer_load_dwordx4 v[228:231], v3, s[40:43], s44 offen offset:1024 nt
    v_mfma_f32_16x16x32_bf16 v[20:23], v[36:39], v[196:199], v[20:23]
    v_and_b32_dpp v40, v72, v16 row_newbcast:8 row_mask:0xf bank_mask:0xf
    v_and_b32_dpp v41, v72, v17 row_newbcast:8 row_mask:0xf bank_mask:0xf
    v_and_b32_dpp v42, v72, v18 row_newbcast:8 row_mask:0xf bank_mask:0xf
    v_and_b32_dpp v43, v72, v19 row_newbcast:8 row_mask:0xf bank_mask:0xf
    s_waitcnt vmcnt(7)
    s_cmpk_gt_u32 s68, 234
    s_cbranch_scc1 L_d234
    s_waitcnt vmcnt(4)
L_d234:
    buffer_load_dwordx4 v[232:235], v3, s[40:43], s44 offen offset:2048 nt
    v_mfma_f32_16x16x32_bf16 v[20:23], v[40:43], v[200:203], v[20:23]
    v_and_b32_dpp v44, v72, v16 row_newbcast:12 row_mask:0xf bank_mask:0xf
    v_and_b32_dpp v45, v72, v17 row_newbcast:12 row_mask:0xf bank_mask:0xf
    v_and_b32_dpp v46, v72, v18 row_newbcast:12 row_mask:0xf bank_mask:0xf
    v_and_b32_dpp v47, v72, v19 row_newbcast:12 row_mask:0xf bank_mask:0xf
    s_waitcnt vmcnt(7)
    s_cmpk_gt_u32 s68, 235
    s_cbranch_scc1 L_d235
    s_waitcnt vmcnt(4)
L_d235:
    buffer_load_dwordx4 v[236:239], v3, s[40:43], s44 offen offset:3072 nt
    v_mfma_f32_16x16x32_bf16 v[20:23], v[44:47], v[204:207], v[20:23]
    v_and_b32_dpp v32, v73, v16 row_newbcast:0 row_mask:0xf bank_mask:0xf
    v_and_b32_dpp v33, v73, v17 row_newbcast:0 row_mask:0xf bank_mask:0xf
    v_and_b32_dpp v34, v73, v18 row_newbcast:0 row_mask:0xf bank_mask:0xf
    v_and_b32_dpp v35, v73, v19 row_newbcast:0 row_mask:0xf bank_mask:0xf
    s_waitcnt vmcnt(7)
    s_cmpk_gt_u32 s68, 236
    s_cbranch_scc1 L_d236
    s_waitcnt vmcnt(4)
L_d236:
    s_mov_b32 s44, 868352
    buffer_load_dwordx4 v[240:243], v3, s[40:43], s44 offen offset:0 nt
    v_mfma_f32_16x16x32_bf16 v[20:23], v[32:35], v[208:211], v[20:23]
    v_and_b32_dpp v36, v73, v16 row_newbcast:4 row_mask:0xf bank_mask:0xf
    v_and_b32_dpp v37, v73, v17 row_newbcast:4 row_mask:0xf bank_mask:0xf
    v_and_b32_dpp v38, v73, v18 row_newbcast:4 row_mask:0xf bank_mask:0xf
    v_and_b32_dpp v39, v73, v19 row_newbcast:4 row_mask:0xf bank_mask:0xf
    s_waitcnt vmcnt(7)
    s_cmpk_gt_u32 s68, 237
    s_cbranch_scc1 L_d237
    s_waitcnt vmcnt(4)
L_d237:
    buffer_load_dwordx4 v[244:247], v3, s[40:43], s44 offen offset:1024 nt
    v_mfma_f32_16x16x32_bf16 v[20:23], v[36:39], v[212:215], v[20:23]
    v_and_b32_dpp v40, v73, v16 row_newbcast:8 row_mask:0xf bank_mask:0xf
    v_and_b32_dpp v41, v73, v17 row_newbcast:8 row_mask:0xf bank_mask:0xf
    v_and_b32_dpp v42, v73, v18 row_newbcast:8 row_mask:0xf bank_mask:0xf
    v_and_b32_dpp v43, v73, v19 row_newbcast:8 row_mask:0xf bank_mask:0xf
    s_waitcnt vmcnt(7)
    s_cmpk_gt_u32 s68, 238
    s_cbranch_scc1 L_d238
    s_waitcnt vmcnt(4)
L_d238:
    buffer_load_dwordx4 v[248:251], v3, s[40:43], s44 offen offset:2048 nt
    v_mfma_f32_16x16x32_bf16 v[20:23], v[40:43], v[216:219], v[20:23]
    v_and_b32_dpp v44, v73, v16 row_newbcast:12 row_mask:0xf bank_mask:0xf
    v_and_b32_dpp v45, v73, v17 row_newbcast:12 row_mask:0xf bank_mask:0xf
    v_and_b32_dpp v46, v73, v18 row_newbcast:12 row_mask:0xf bank_mask:0xf
    v_and_b32_dpp v47, v73, v19 row_newbcast:12 row_mask:0xf bank_mask:0xf
    s_waitcnt vmcnt(7)
    s_cmpk_gt_u32 s68, 239
    s_cbranch_scc1 L_d239
    s_waitcnt vmcnt(4)
L_d239:
    buffer_load_dwordx4 v[252:255], v3, s[40:43], s44 offen offset:3072 nt
    v_mfma_f32_16x16x32_bf16 v[20:23], v[44:47], v[220:223], v[20:23]
    v_and_b32_dpp v32, v74, v16 row_newbcast:0 row_mask:0xf bank_mask:0xf
    v_and_b32_dpp v33, v74, v17 row_newbcast:0 row_mask:0xf bank_mask:0xf
    v_and_b32_dpp v34, v74, v18 row_newbcast:0 row_mask:0xf bank_mask:0xf
    v_and_b32_dpp v35, v74, v19 row_newbcast:0 row_mask:0xf bank_mask:0xf
    s_waitcnt vmcnt(7)
    s_cmpk_gt_u32 s68, 240
    s_cbranch_scc1 L_d240
    s_waitcnt vmcnt(4)
L_d240:
    s_mov_b32 s44, 917504
    buffer_load_dwordx4 v[80:83], v3, s[40:43], s44 offen offset:0 nt
    v_mfma_f32_16x16x32_bf16 v[20:23], v[32:35], v[224:227], v[20:23]
    v_and_b32_dpp v36, v74, v16 row_newbcast:4 row_mask:0xf bank_mask:0xf
    v_and_b32_dpp v37, v74, v17 row_newbcast:4 row_mask:0xf bank_mask:0xf
    v_and_b32_dpp v38, v74, v18 row_newbcast:4 row_mask:0xf bank_mask:0xf
    v_and_b32_dpp v39, v74, v19 row_newbcast:4 row_mask:0xf bank_mask:0xf
    s_waitcnt vmcnt(7)
    s_cmpk_gt_u32 s68, 241
    s_cbranch_scc1 L_d241
    s_waitcnt vmcnt(4)
L_d241:
    buffer_load_dwordx4 v[84:87], v3, s[40:43], s44 offen offset:1024 nt
    v_mfma_f32_16x16x32_bf16 v[20:23], v[36:39], v[228:231], v[20:23]
    v_and_b32_dpp v40, v74, v16 row_newbcast:8 row_mask:0xf bank_mask:0xf
    v_and_b32_dpp v41, v74, v17 row_newbcast:8 row_mask:0xf bank_mask:0xf
    v_and_b32_dpp v42, v74, v18 row_newbcast:8 row_mask:0xf bank_mask:0xf
    v_and_b32_dpp v43, v74, v19 row_newbcast:8 row_mask:0xf bank_mask:0xf
    s_waitcnt vmcnt(7)
    s_cmpk_gt_u32 s68, 242
    s_cbranch_scc1 L_d242
    s_waitcnt vmcnt(4)
L_d242:
    buffer_load_dwordx4 v[88:91], v3, s[40:43], s44 offen offset:2048 nt
    v_mfma_f32_16x16x32_bf16 v[20:23], v[40:43], v[232:235], v[20:23]
    v_and_b32_dpp v44, v74, v16 row_newbcast:12 row_mask:0xf bank_mask:0xf
    v_and_b32_dpp v45, v74, v17 row_newbcast:12 row_mask:0xf bank_mask:0xf
    v_and_b32_dpp v46, v74, v18 row_newbcast:12 row_mask:0xf bank_mask:0xf
    v_and_b32_dpp v47, v74, v19 row_newbcast:12 row_mask:0xf bank_mask:0xf
    s_waitcnt vmcnt(7)
    s_cmpk_gt_u32 s68, 243
    s_cbranch_scc1 L_d243
    s_waitcnt vmcnt(4)
L_d243:
    buffer_load_dwordx4 v[92:95], v3, s[40:43], s44 offen offset:3072 nt
    v_mfma_f32_16x16x32_bf16 v[20:23], v[44:47], v[236:239], v[20:23]
    v_and_b32_dpp v32, v75, v16 row_newbcast:0 row_mask:0xf bank_mask:0xf
    v_and_b32_dpp v33, v75, v17 row_newbcast:0 row_mask:0xf bank_mask:0xf
    v_and_b32_dpp v34, v75, v18 row_newbcast:0 row_mask:0xf bank_mask:0xf
    v_and_b32_dpp v35, v75, v19 row_newbcast:0 row_mask:0xf bank_mask:0xf
    s_waitcnt vmcnt(7)
    s_cmpk_gt_u32 s68, 244
    s_cbranch_scc1 L_d244
    s_waitcnt vmcnt(4)
L_d244:
    s_mov_b32 s44, 933888
    buffer_load_dwordx4 v[96:99], v3, s[40:43], s44 offen offset:0 nt
    v_mfma_f32_16x16x32_bf16 v[20:23], v[32:35], v[240:243], v[20:23]
    v_and_b32_dpp v36, v75, v16 row_newbcast:4 row_mask:0xf bank_mask:0xf
    v_and_b32_dpp v37, v75, v17 row_newbcast:4 row_mask:0xf bank_mask:0xf
    v_and_b32_dpp v38, v75, v18 row_newbcast:4 row_mask:0xf bank_mask:0xf
    v_and_b32_dpp v39, v75, v19 row_newbcast:4 row_mask:0xf bank_mask:0xf
    s_waitcnt vmcnt(7)
    s_cmpk_gt_u32 s68, 245
    s_cbranch_scc1 L_d245
    s_waitcnt vmcnt(4)
L_d245:
    buffer_load_dwordx4 v[100:103], v3, s[40:43], s44 offen offset:1024 nt
    v_mfma_f32_16x16x32_bf16 v[20:23], v[36:39], v[244:247], v[20:23]
    v_and_b32_dpp v40, v75, v16 row_newbcast:8 row_mask:0xf bank_mask:0xf
    v_and_b32_dpp v41, v75, v17 row_newbcast:8 row_mask:0xf bank_mask:0xf
    v_and_b32_dpp v42, v75, v18 row_newbcast:8 row_mask:0xf bank_mask:0xf
    v_and_b32_dpp v43, v75, v19 row_newbcast:8 row_mask:0xf bank_mask:0xf
    s_waitcnt vmcnt(7)
    buffer_load_dwordx4 v[104:107], v3, s[40:43], s44 offen offset:2048 nt
    v_mfma_f32_16x16x32_bf16 v[20:23], v[40:43], v[248:251], v[20:23]
    v_and_b32_dpp v44, v75, v16 row_newbcast:12 row_mask:0xf bank_mask:0xf
    v_and_b32_dpp v45, v75, v17 row_newbcast:12 row_mask:0xf bank_mask:0xf
    v_and_b32_dpp v46, v75, v18 row_newbcast:12 row_mask:0xf bank_mask:0xf
    v_and_b32_dpp v47, v75, v19 row_newbcast:12 row_mask:0xf bank_mask:0xf
    s_waitcnt vmcnt(7)
    buffer_load_dwordx4 v[108:111], v3, s[40:43], s44 offen offset:3072 nt
    v_mfma_f32_16x16x32_bf16 v[20:23], v[44:47], v[252:255], v[20:23]
    v_and_b32_dpp v32, v76, v16 row_newbcast:0 row_mask:0xf bank_mask:0xf
    v_and_b32_dpp v33, v76, v17 row_newbcast:0 row_mask:0xf bank_mask:0xf
    v_and_b32_dpp v34, v76, v18 row_newbcast:0 row_mask:0xf bank_mask:0xf
    v_and_b32_dpp v35, v76, v19 row_newbcast:0 row_mask:0xf bank_mask:0xf
    s_waitcnt vmcnt(7)
    s_mov_b32 s44, 983040
    buffer_load_dwordx4 v[112:115], v3, s[40:43], s44 offen offset:0 nt
    v_mfma_f32_16x16x32_bf16 v[20:23], v[32:35], v[80:83], v[20:23]
    v_and_b32_dpp v36, v76, v16 row_newbcast:4 row_mask:0xf bank_mask:0xf
    v_and_b32_dpp v37, v76, v17 row_newbcast:4 row_mask:0xf bank_mask:0xf
    v_and_b32_dpp v38, v76, v18 row_newbcast:4 row_mask:0xf bank_mask:0xf
    v_and_b32_dpp v39, v76, v19 row_newbcast:4 row_mask:0xf bank_mask:0xf
    s_waitcnt vmcnt(7)
    buffer_load_dwordx4 v[116:119], v3, s[40:43], s44 offen offset:1024 nt
    v_mfma_f32_16x16x32_bf16 v[20:23], v[36:39], v[84:87], v[20:23]
    v_and_b32_dpp v40, v76, v16 row_newbcast:8 row_mask:0xf bank_mask:0xf
    v_and_b32_dpp v41, v76, v17 row_newbcast:8 row_mask:0xf bank_mask:0xf
    v_and_b32_dpp v42, v76, v18 row_newbcast:8 row_mask:0xf bank_mask:0xf
    v_and_b32_dpp v43, v76, v19 row_newbcast:8 row_mask:0xf bank_mask:0xf
    s_waitcnt vmcnt(7)
    buffer_load_dwordx4 v[120:123], v3, s[40:43], s44 offen offset:2048 nt
    v_mfma_f32_16x16x32_bf16 v[20:23], v[40:43], v[88:91], v[20:23]
    v_and_b32_dpp v44, v76, v16 row_newbcast:12 row_mask:0xf bank_mask:0xf
    v_and_b32_dpp v45, v76, v17 row_newbcast:12 row_mask:0xf bank_mask:0xf
    v_and_b32_dpp v46, v76, v18 row_newbcast:12 row_mask:0xf bank_mask:0xf
    v_and_b32_dpp v47, v76, v19 row_newbcast:12 row_mask:0xf bank_mask:0xf
    s_waitcnt vmcnt(7)
    buffer_load_dwordx4 v[124:127], v3, s[40:43], s44 offen offset:3072 nt
    v_mfma_f32_16x16x32_bf16 v[20:23], v[44:47], v[92:95], v[20:23]
    v_and_b32_dpp v32, v77, v16 row_newbcast:0 row_mask:0xf bank_mask:0xf
    v_and_b32_dpp v33, v77, v17 row_newbcast:0 row_mask:0xf bank_mask:0xf
    v_and_b32_dpp v34, v77, v18 row_newbcast:0 row_mask:0xf bank_mask:0xf
    v_and_b32_dpp v35, v77, v19 row_newbcast:0 row_mask:0xf bank_mask:0xf
    s_waitcnt vmcnt(7)
    s_mov_b32 s44, 999424
    buffer_load_dwordx4 v[128:131], v3, s[40:43], s44 offen offset:0 nt
    v_mfma_f32_16x16x32_bf16 v[20:23], v[32:35], v[96:99], v[20:23]
    v_and_b32_dpp v36, v77, v16 row_newbcast:4 row_mask:0xf bank_mask:0xf
    v_and_b32_dpp v37, v77, v17 row_newbcast:4 row_mask:0xf bank_mask:0xf
    v_and_b32_dpp v38, v77, v18 row_newbcast:4 row_mask:0xf bank_mask:0xf
    v_and_b32_dpp v39, v77, v19 row_newbcast:4 row_mask:0xf bank_mask:0xf
    s_waitcnt vmcnt(7)
    buffer_load_dwordx4 v[132:135], v3, s[40:43], s44 offen offset:1024 nt
    v_mfma_f32_16x16x32_bf16 v[20:23], v[36:39], v[100:103], v[20:23]
    v_and_b32_dpp v40, v77, v16 row_newbcast:8 row_mask:0xf bank_mask:0xf
    v_and_b32_dpp v41, v77, v17 row_newbcast:8 row_mask:0xf bank_mask:0xf
    v_and_b32_dpp v42, v77, v18 row_newbcast:8 row_mask:0xf bank_mask:0xf
    v_and_b32_dpp v43, v77, v19 row_newbcast:8 row_mask:0xf bank_mask:0xf
    s_waitcnt vmcnt(7)
    buffer_load_dwordx4 v[136:139], v3, s[40:43], s44 offen offset:2048 nt
    v_mfma_f32_16x16x32_bf16 v[20:23], v[40:43], v[104:107], v[20:23]
    v_and_b32_dpp v44, v77, v16 row_newbcast:12 row_mask:0xf bank_mask:0xf
    v_and_b32_dpp v45, v77, v17 row_newbcast:12 row_mask:0xf bank_mask:0xf
    v_and_b32_dpp v46, v77, v18 row_newbcast:12 row_mask:0xf bank_mask:0xf
    v_and_b32_dpp v47, v77, v19 row_newbcast:12 row_mask:0xf bank_mask:0xf
    s_waitcnt vmcnt(7)
    buffer_load_dwordx4 v[140:143], v3, s[40:43], s44 offen offset:3072 nt
    v_mfma_f32_16x16x32_bf16 v[20:23], v[44:47], v[108:111], v[20:23]
    v_and_b32_dpp v32, v78, v16 row_newbcast:0 row_mask:0xf bank_mask:0xf
    v_and_b32_dpp v33, v78, v17 row_newbcast:0 row_mask:0xf bank_mask:0xf
    v_and_b32_dpp v34, v78, v18 row_newbcast:0 row_mask:0xf bank_mask:0xf
    v_and_b32_dpp v35, v78, v19 row_newbcast:0 row_mask:0xf bank_mask:0xf
    s_waitcnt vmcnt(7)
    s_nop 0
    v_mfma_f32_16x16x32_bf16 v[20:23], v[32:35], v[112:115], v[20:23]
    v_and_b32_dpp v36, v78, v16 row_newbcast:4 row_mask:0xf bank_mask:0xf
    v_and_b32_dpp v37, v78, v17 row_newbcast:4 row_mask:0xf bank_mask:0xf
    v_and_b32_dpp v38, v78, v18 row_newbcast:4 row_mask:0xf bank_mask:0xf
    v_and_b32_dpp v39, v78, v19 row_newbcast:4 row_mask:0xf bank_mask:0xf
    s_waitcnt vmcnt(6)
    s_nop 0
    v_mfma_f32_16x16x32_bf16 v[20:23], v[36:39], v[116:119], v[20:23]
    v_and_b32_dpp v40, v78, v16 row_newbcast:8 row_mask:0xf bank_mask:0xf
    v_and_b32_dpp v41, v78, v17 row_newbcast:8 row_mask:0xf bank_mask:0xf
    v_and_b32_dpp v42, v78, v18 row_newbcast:8 row_mask:0xf bank_mask:0xf
    v_and_b32_dpp v43, v78, v19 row_newbcast:8 row_mask:0xf bank_mask:0xf
    s_waitcnt vmcnt(5)
    s_nop 0
    v_mfma_f32_16x16x32_bf16 v[20:23], v[40:43], v[120:123], v[20:23]
    v_and_b32_dpp v44, v78, v16 row_newbcast:12 row_mask:0xf bank_mask:0xf
    v_and_b32_dpp v45, v78, v17 row_newbcast:12 row_mask:0xf bank_mask:0xf
    v_and_b32_dpp v46, v78, v18 row_newbcast:12 row_mask:0xf bank_mask:0xf
    v_and_b32_dpp v47, v78, v19 row_newbcast:12 row_mask:0xf bank_mask:0xf
    s_waitcnt vmcnt(4)
    s_nop 0
    v_mfma_f32_16x16x32_bf16 v[20:23], v[44:47], v[124:127], v[20:23]
    v_and_b32_dpp v32, v79, v16 row_newbcast:0 row_mask:0xf bank_mask:0xf
    v_and_b32_dpp v33, v79, v17 row_newbcast:0 row_mask:0xf bank_mask:0xf
    v_and_b32_dpp v34, v79, v18 row_newbcast:0 row_mask:0xf bank_mask:0xf
    v_and_b32_dpp v35, v79, v19 row_newbcast:0 row_mask:0xf bank_mask:0xf
    s_waitcnt vmcnt(3)
    s_nop 0
    v_mfma_f32_16x16x32_bf16 v[20:23], v[32:35], v[128:131], v[20:23]
    v_and_b32_dpp v36, v79, v16 row_newbcast:4 row_mask:0xf bank_mask:0xf
    v_and_b32_dpp v37, v79, v17 row_newbcast:4 row_mask:0xf bank_mask:0xf
    v_and_b32_dpp v38, v79, v18 row_newbcast:4 row_mask:0xf bank_mask:0xf
    v_and_b32_dpp v39, v79, v19 row_newbcast:4 row_mask:0xf bank_mask:0xf
    s_waitcnt vmcnt(2)
    s_nop 0
    v_mfma_f32_16x16x32_bf16 v[20:23], v[36:39], v[132:135], v[20:23]
    v_and_b32_dpp v40, v79, v16 row_newbcast:8 row_mask:0xf bank_mask:0xf
    v_and_b32_dpp v41, v79, v17 row_newbcast:8 row_mask:0xf bank_mask:0xf
    v_and_b32_dpp v42, v79, v18 row_newbcast:8 row_mask:0xf bank_mask:0xf
    v_and_b32_dpp v43, v79, v19 row_newbcast:8 row_mask:0xf bank_mask:0xf
    s_waitcnt vmcnt(1)
    s_nop 0
    v_mfma_f32_16x16x32_bf16 v[20:23], v[40:43], v[136:139], v[20:23]
    v_and_b32_dpp v44, v79, v16 row_newbcast:12 row_mask:0xf bank_mask:0xf
    v_and_b32_dpp v45, v79, v17 row_newbcast:12 row_mask:0xf bank_mask:0xf
    v_and_b32_dpp v46, v79, v18 row_newbcast:12 row_mask:0xf bank_mask:0xf
    v_and_b32_dpp v47, v79, v19 row_newbcast:12 row_mask:0xf bank_mask:0xf
    s_waitcnt vmcnt(0)
    s_nop 0
    v_mfma_f32_16x16x32_bf16 v[20:23], v[44:47], v[140:143], v[20:23]
    s_mov_b32 exec_hi, 0
    s_nop 6
    v_cvt_pk_bf16_f32 v8, v20, v21
    v_cvt_pk_bf16_f32 v9, v22, v23
    ds_write2_b32 v5, v8, v9 offset0:0 offset1:4
    s_waitcnt lgkmcnt(0)
    s_barrier
    s_cmp_lg_u32 s3, 0
    s_cbranch_scc1 L_sdone
    s_mov_b32 exec_hi, -1
    s_mov_b32 s52, s26
    s_and_b32 s53, s27, 0xffff
    s_mov_b32 s54, 33554432
    s_mov_b32 s55, 0x20000
    s_mov_b32 s40, s22
    s_and_b32 s41, s23, 0xffff
    s_mov_b32 s42, 4096
    s_mov_b32 s43, 0x20000
    s_mov_b32 s62, 0x40000
    s_mov_b32 s47, 0
    s_branch L_fin
L_sdone:
    s_endpgm
L_h1:
    s_lshl_b32 s33, s33, 1
    s_add_u32 s33, s33, s32
    s_lshl_b32 s33, s33, 12
    s_mov_b32 s52, s26
    s_and_b32 s53, s27, 0xffff
    s_mov_b32 s54, 33554432
    s_mov_b32 s55, 0x20000
    s_and_b32 s51, s35, 1
    s_cselect_b32 s64, s18, s16
    s_cselect_b32 s65, s19, s17
    s_mov_b32 s56, s64
    s_and_b32 s57, s65, 0xffff
    s_mov_b32 s58, 1835008
    s_mov_b32 s59, 0x20000
    s_mul_i32 s45, s28, 7
    s_add_u32 s45, s45, 1
    s_sub_u32 s45, s45, s51
    s_lshr_b32 s45, s45, 1
    s_lshl_b32 s45, s45, 7
    s_lshr_b32 s46, s35, 1
    s_lshl1_add_u32 s46, s29, s46
    s_mul_i32 s46, s46, 28672
    s_add_u32 s45, s45, s46
    v_and_b32 v40, 7, v0
    v_mul_u32_u24 v40, 0xe00, v40
    v_lshl_add_u32 v40, v1, 7, v40
    s_xor_b32 s46, s28, s51
    s_and_b32 s46, s46, 1
    s_cselect_b32 exec_hi, 0xffff, -1
    buffer_load_dword v42, v40, s[56:59], s45 offen
    s_mov_b32 exec_hi, -1
    s_lshl2_add_u32 s45, s29, s35
    s_mul_i32 s45, s45, 4096
    s_mul_i32 s46, s28, 256
    s_add_u32 s45, s45, s46
    s_add_u32 s45, s45, 1310720
    v_lshrrev_b32 v40, 1, v1
    v_mul_u32_u24 v40, 2048, v40
    v_and_b32 v44, 1, v1
    v_lshl_add_u32 v40, v44, 7, v40
    buffer_load_dword v44, v40, s[52:55], s45 offen sc1
    v_and_b32 v8, 1, v0
    v_lshlrev_b32 v8, 4, v8
    v_mov_b32 v15, 0xffff
    v_lshlrev_b32 v8, v8, v15
    v_bfe_u32 v15, v0, 1, 3
    v_cmp_eq_u32 vcc, 0, v15
    s_nop 1
    v_cndmask_b32 v12, 0, v8, vcc
    v_cmp_eq_u32 vcc, 1, v15
    s_nop 1
    v_cndmask_b32 v13, 0, v8, vcc
    v_cmp_eq_u32 vcc, 2, v15
    s_nop 1
    v_cndmask_b32 v14, 0, v8, vcc
    v_cmp_eq_u32 vcc, 3, v15
    s_nop 1
    v_cndmask_b32 v15, 0, v8, vcc
    s_waitcnt vmcnt(5)
    s_waitcnt vmcnt(4)
    buffer_load_dwordx4 v[140:143], v6, s[40:43], s44 offen
    s_add_u32 s44, s44, 0x2000
    s_and_b32 s44, s44, 0x3ffff
    s_waitcnt vmcnt(4)
    buffer_load_dwordx4 v[144:147], v6, s[40:43], s44 offen
    s_add_u32 s44, s44, 0x2000
    s_and_b32 s44, s44, 0x3ffff
    s_waitcnt vmcnt(4)
    buffer_load_dwordx4 v[148:151], v6, s[40:43], s44 offen
    s_add_u32 s44, s44, 0x2000
    s_and_b32 s44, s44, 0x3ffff
    v_lshlrev_b32 v32, 16, v28
    v_and_b32 v33, 0xffff0000, v28
    v_lshlrev_b32 v34, 16, v29
    v_and_b32 v35, 0xffff0000, v29
    v_lshlrev_b32 v36, 16, v30
    v_and_b32 v37, 0xffff0000, v30
    v_lshlrev_b32 v38, 16, v31
    v_and_b32 v39, 0xffff0000, v31
    v_add_f32 v8, v32, v33
    v_add_f32 v9, v34, v35
    v_add_f32 v10, v36, v37
    v_add_f32 v11, v38, v39
    v_add_f32 v8, v8, v9
    v_add_f32 v10, v10, v11
    v_add_f32 v8, v8, v10
    s_nop 1
    v_add_f32_dpp v8, v8, v8 quad_perm:[1,0,3,2] row_mask:0xf bank_mask:0xf
    s_nop 1
    v_add_f32_dpp v8, v8, v8 quad_perm:[2,3,0,1] row_mask:0xf bank_mask:0xf
    s_nop 1
    v_add_f32_dpp v8, v8, v8 row_half_mirror row_mask:0xf bank_mask:0xf
    s_nop 1
    v_add_f32_dpp v8, v8, v8 row_mirror row_mask:0xf bank_mask:0xf
    v_mov_b32 v9, v8
    s_nop 1
    v_permlane16_swap_b32 v8, v9
    v_add_f32 v8, v8, v9
    v_mov_b32 v9, v8
    s_nop 1
    v_permlane32_swap_b32 v8, v9
    v_add_f32 v8, v8, v9
    v_mul_f32 v8, 0x3b000000, v8
    v_sub_f32 v32, v32, v8
    v_sub_f32 v33, v33, v8
    v_sub_f32 v34, v34, v8
    v_sub_f32 v35, v35, v8
    v_sub_f32 v36, v36, v8
    v_sub_f32 v37, v37, v8
    v_sub_f32 v38, v38, v8
    v_sub_f32 v39, v39, v8
    v_mul_f32 v9, v32, v32
    v_mul_f32 v10, v33, v33
    v_fmac_f32 v9, v34, v34
    v_fmac_f32 v10, v35, v35
    v_fmac_f32 v9, v36, v36
    v_fmac_f32 v10, v37, v37
    v_fmac_f32 v9, v38, v38
    v_fmac_f32 v10, v39, v39
    v_add_f32 v9, v9, v10
    s_nop 1
    v_add_f32_dpp v9, v9, v9 quad_perm:[1,0,3,2] row_mask:0xf bank_mask:0xf
    s_nop 1
    v_add_f32_dpp v9, v9, v9 quad_perm:[2,3,0,1] row_mask:0xf bank_mask:0xf
    s_nop 1
    v_add_f32_dpp v9, v9, v9 row_half_mirror row_mask:0xf bank_mask:0xf
    s_nop 1
    v_add_f32_dpp v9, v9, v9 row_mirror row_mask:0xf bank_mask:0xf
    v_mov_b32 v10, v9
    s_nop 1
    v_permlane16_swap_b32 v9, v10
    v_add_f32 v9, v9, v10
    v_mov_b32 v10, v9
    s_nop 1
    v_permlane32_swap_b32 v9, v10
    v_add_f32 v9, v9, v10
    v_mul_f32 v9, 0x3b000000, v9
    v_cvt_pk_bf16_f32 v8, 0, v8
    v_cvt_pk_bf16_f32 v9, 0, v9
    v_add_f32 v9, 0x37280000, v9
    v_cvt_pk_bf16_f32 v9, 0, v9
    v_sqrt_f32 v9, v9
    s_nop 0
    v_cvt_pk_bf16_f32 v9, 0, v9
    v_rcp_f32 v9, v9
    v_lshlrev_b32 v10, 16, v7
    v_and_b32 v11, 0xffff0000, v7
    v_sub_f32 v10, v10, v8
    v_cvt_pk_bf16_f32 v10, 0, v10
    v_mul_f32 v10, v10, v9
    v_cvt_pk_bf16_f32 v10, v10, v10
    v_sub_f32 v11, v11, v8
    v_cvt_pk_bf16_f32 v11, 0, v11
    v_mul_f32 v11, v11, v9
    v_cvt_pk_bf16_f32 v11, v11, v11
    v_and_b32_dpp v16, v10, v12 row_newbcast:0 row_mask:0xf bank_mask:0xf
    v_and_b32_dpp v17, v10, v13 row_newbcast:0 row_mask:0xf bank_mask:0xf
    v_and_b32_dpp v18, v10, v14 row_newbcast:0 row_mask:0xf bank_mask:0xf
    v_and_b32_dpp v19, v10, v15 row_newbcast:0 row_mask:0xf bank_mask:0xf
    v_and_b32_dpp v20, v11, v12 row_newbcast:0 row_mask:0xf bank_mask:0xf
    v_and_b32_dpp v21, v11, v13 row_newbcast:0 row_mask:0xf bank_mask:0xf
    v_and_b32_dpp v22, v11, v14 row_newbcast:0 row_mask:0xf bank_mask:0xf
    v_and_b32_dpp v23, v11, v15 row_newbcast:0 row_mask:0xf bank_mask:0xf
    v_mfma_f32_16x16x32_bf16 v[24:27], v[16:19], v[128:131], 0
    v_and_b32_dpp v16, v10, v12 row_newbcast:1 row_mask:0xf bank_mask:0xf
    v_and_b32_dpp v17, v10, v13 row_newbcast:1 row_mask:0xf bank_mask:0xf
    v_and_b32_dpp v18, v10, v14 row_newbcast:1 row_mask:0xf bank_mask:0xf
    v_and_b32_dpp v19, v10, v15 row_newbcast:1 row_mask:0xf bank_mask:0xf
    v_mfma_f32_16x16x32_bf16 v[24:27], v[20:23], v[132:135], v[24:27]
    v_and_b32_dpp v20, v11, v12 row_newbcast:1 row_mask:0xf bank_mask:0xf
    v_and_b32_dpp v21, v11, v13 row_newbcast:1 row_mask:0xf bank_mask:0xf
    v_and_b32_dpp v22, v11, v14 row_newbcast:1 row_mask:0xf bank_mask:0xf
    v_and_b32_dpp v23, v11, v15 row_newbcast:1 row_mask:0xf bank_mask:0xf
    v_mfma_f32_16x16x32_bf16 v[24:27], v[16:19], v[136:139], v[24:27]
    s_waitcnt vmcnt(2)
    buffer_load_dwordx4 v[152:155], v6, s[40:43], s44 offen
    s_add_u32 s44, s44, 0x2000
    s_and_b32 s44, s44, 0x3ffff
    v_and_b32_dpp v16, v10, v12 row_newbcast:2 row_mask:0xf bank_mask:0xf
    v_and_b32_dpp v17, v10, v13 row_newbcast:2 row_mask:0xf bank_mask:0xf
    v_and_b32_dpp v18, v10, v14 row_newbcast:2 row_mask:0xf bank_mask:0xf
    v_and_b32_dpp v19, v10, v15 row_newbcast:2 row_mask:0xf bank_mask:0xf
    v_mfma_f32_16x16x32_bf16 v[24:27], v[20:23], v[140:143], v[24:27]
    s_waitcnt vmcnt(2)
    buffer_load_dwordx4 v[156:159], v6, s[40:43], s44 offen
    s_add_u32 s44, s44, 0x2000
    s_and_b32 s44, s44, 0x3ffff
    v_and_b32_dpp v20, v11, v12 row_newbcast:2 row_mask:0xf bank_mask:0xf
    v_and_b32_dpp v21, v11, v13 row_newbcast:2 row_mask:0xf bank_mask:0xf
    v_and_b32_dpp v22, v11, v14 row_newbcast:2 row_mask:0xf bank_mask:0xf
    v_and_b32_dpp v23, v11, v15 row_newbcast:2 row_mask:0xf bank_mask:0xf
    v_mfma_f32_16x16x32_bf16 v[24:27], v[16:19], v[144:147], v[24:27]
    s_waitcnt vmcnt(2)
    buffer_load_dwordx4 v[160:163], v6, s[40:43], s44 offen
    s_add_u32 s44, s44, 0x2000
    s_and_b32 s44, s44, 0x3ffff
    v_and_b32_dpp v16, v10, v12 row_newbcast:3 row_mask:0xf bank_mask:0xf
    v_and_b32_dpp v17, v10, v13 row_newbcast:3 row_mask:0xf bank_mask:0xf
    v_and_b32_dpp v18, v10, v14 row_newbcast:3 row_mask:0xf bank_mask:0xf
    v_and_b32_dpp v19, v10, v15 row_newbcast:3 row_mask:0xf bank_mask:0xf
    v_mfma_f32_16x16x32_bf16 v[24:27], v[20:23], v[148:151], v[24:27]
    s_waitcnt vmcnt(2)
    buffer_load_dwordx4 v[164:167], v6, s[40:43], s44 offen
    s_add_u32 s44, s44, 0x2000
    s_and_b32 s44, s44, 0x3ffff
    v_and_b32_dpp v20, v11, v12 row_newbcast:3 row_mask:0xf bank_mask:0xf
    v_and_b32_dpp v21, v11, v13 row_newbcast:3 row_mask:0xf bank_mask:0xf
    v_and_b32_dpp v22, v11, v14 row_newbcast:3 row_mask:0xf bank_mask:0xf
    v_and_b32_dpp v23, v11, v15 row_newbcast:3 row_mask:0xf bank_mask:0xf
    v_mfma_f32_16x16x32_bf16 v[24:27], v[16:19], v[152:155], v[24:27]
    s_waitcnt vmcnt(2)
    buffer_load_dwordx4 v[168:171], v6, s[40:43], s44 offen
    s_add_u32 s44, s44, 0x2000
    s_and_b32 s44, s44, 0x3ffff
    v_and_b32_dpp v16, v10, v12 row_newbcast:4 row_mask:0xf bank_mask:0xf
    v_and_b32_dpp v17, v10, v13 row_newbcast:4 row_mask:0xf bank_mask:0xf
    v_and_b32_dpp v18, v10, v14 row_newbcast:4 row_mask:0xf bank_mask:0xf
    v_and_b32_dpp v19, v10, v15 row_newbcast:4 row_mask:0xf bank_mask:0xf
    v_mfma_f32_16x16x32_bf16 v[24:27], v[20:23], v[156:159], v[24:27]
    s_waitcnt vmcnt(2)
    buffer_load_dwordx4 v[172:175], v6, s[40:43], s44 offen
    s_add_u32 s44, s44, 0x2000
    s_and_b32 s44, s44, 0x3ffff
    v_and_b32_dpp v20, v11, v12 row_newbcast:4 row_mask:0xf bank_mask:0xf
    v_and_b32_dpp v21, v11, v13 row_newbcast:4 row_mask:0xf bank_mask:0xf
    v_and_b32_dpp v22, v11, v14 row_newbcast:4 row_mask:0xf bank_mask:0xf
    v_and_b32_dpp v23, v11, v15 row_newbcast:4 row_mask:0xf bank_mask:0xf
    v_mfma_f32_16x16x32_bf16 v[24:27], v[16:19], v[160:163], v[24:27]
    s_waitcnt vmcnt(2)
    buffer_load_dwordx4 v[176:179], v6, s[40:43], s44 offen
    s_add_u32 s44, s44, 0x2000
    s_and_b32 s44, s44, 0x3ffff
    v_and_b32_dpp v16, v10, v12 row_newbcast:5 row_mask:0xf bank_mask:0xf
    v_and_b32_dpp v17, v10, v13 row_newbcast:5 row_mask:0xf bank_mask:0xf
    v_and_b32_dpp v18, v10, v14 row_newbcast:5 row_mask:0xf bank_mask:0xf
    v_and_b32_dpp v19, v10, v15 row_newbcast:5 row_mask:0xf bank_mask:0xf
    v_mfma_f32_16x16x32_bf16 v[24:27], v[20:23], v[164:167], v[24:27]
    s_waitcnt vmcnt(2)
    buffer_load_dwordx4 v[180:183], v6, s[40:43], s44 offen
    s_add_u32 s44, s44, 0x2000
    s_and_b32 s44, s44, 0x3ffff
    v_and_b32_dpp v20, v11, v12 row_newbcast:5 row_mask:0xf bank_mask:0xf
    v_and_b32_dpp v21, v11, v13 row_newbcast:5 row_mask:0xf bank_mask:0xf
    v_and_b32_dpp v22, v11, v14 row_newbcast:5 row_mask:0xf bank_mask:0xf
    v_and_b32_dpp v23, v11, v15 row_newbcast:5 row_mask:0xf bank_mask:0xf
    v_mfma_f32_16x16x32_bf16 v[24:27], v[16:19], v[168:171], v[24:27]
    s_waitcnt vmcnt(2)
    buffer_load_dwordx4 v[184:187], v6, s[40:43], s44 offen
    s_add_u32 s44, s44, 0x2000
    s_and_b32 s44, s44, 0x3ffff
    v_and_b32_dpp v16, v10, v12 row_newbcast:6 row_mask:0xf bank_mask:0xf
    v_and_b32_dpp v17, v10, v13 row_newbcast:6 row_mask:0xf bank_mask:0xf
    v_and_b32_dpp v18, v10, v14 row_newbcast:6 row_mask:0xf bank_mask:0xf
    v_and_b32_dpp v19, v10, v15 row_newbcast:6 row_mask:0xf bank_mask:0xf
    v_mfma_f32_16x16x32_bf16 v[24:27], v[20:23], v[172:175], v[24:27]
    s_waitcnt vmcnt(2)
    buffer_load_dwordx4 v[188:191], v6, s[40:43], s44 offen
    s_add_u32 s44, s44, 0x2000
    s_and_b32 s44, s44, 0x3ffff
    v_and_b32_dpp v20, v11, v12 row_newbcast:6 row_mask:0xf bank_mask:0xf
    v_and_b32_dpp v21, v11, v13 row_newbcast:6 row_mask:0xf bank_mask:0xf
    v_and_b32_dpp v22, v11, v14 row_newbcast:6 row_mask:0xf bank_mask:0xf
    v_and_b32_dpp v23, v11, v15 row_newbcast:6 row_mask:0xf bank_mask:0xf
    v_mfma_f32_16x16x32_bf16 v[24:27], v[16:19], v[176:179], v[24:27]
    s_waitcnt vmcnt(2)
    buffer_load_dwordx4 v[192:195], v6, s[40:43], s44 offen
    s_add_u32 s44, s44, 0x2000
    s_and_b32 s44, s44, 0x3ffff
    v_and_b32_dpp v16, v10, v12 row_newbcast:7 row_mask:0xf bank_mask:0xf
    v_and_b32_dpp v17, v10, v13 row_newbcast:7 row_mask:0xf bank_mask:0xf
    v_and_b32_dpp v18, v10, v14 row_newbcast:7 row_mask:0xf bank_mask:0xf
    v_and_b32_dpp v19, v10, v15 row_newbcast:7 row_mask:0xf bank_mask:0xf
    v_mfma_f32_16x16x32_bf16 v[24:27], v[20:23], v[180:183], v[24:27]
    s_waitcnt vmcnt(2)
    buffer_load_dwordx4 v[196:199], v6, s[40:43], s44 offen
    s_add_u32 s44, s44, 0x2000
    s_and_b32 s44, s44, 0x3ffff
    v_and_b32_dpp v20, v11, v12 row_newbcast:7 row_mask:0xf bank_mask:0xf
    v_and_b32_dpp v21, v11, v13 row_newbcast:7 row_mask:0xf bank_mask:0xf
    v_and_b32_dpp v22, v11, v14 row_newbcast:7 row_mask:0xf bank_mask:0xf
    v_and_b32_dpp v23, v11, v15 row_newbcast:7 row_mask:0xf bank_mask:0xf
    v_mfma_f32_16x16x32_bf16 v[24:27], v[16:19], v[184:187], v[24:27]
    s_waitcnt vmcnt(2)
    buffer_load_dwordx4 v[200:203], v6, s[40:43], s44 offen
    s_add_u32 s44, s44, 0x2000
    s_and_b32 s44, s44, 0x3ffff
    v_and_b32_dpp v16, v10, v12 row_newbcast:8 row_mask:0xf bank_mask:0xf
    v_and_b32_dpp v17, v10, v13 row_newbcast:8 row_mask:0xf bank_mask:0xf
    v_and_b32_dpp v18, v10, v14 row_newbcast:8 row_mask:0xf bank_mask:0xf
    v_and_b32_dpp v19, v10, v15 row_newbcast:8 row_mask:0xf bank_mask:0xf
    v_mfma_f32_16x16x32_bf16 v[24:27], v[20:23], v[188:191], v[24:27]
    s_waitcnt vmcnt(2)
    buffer_load_dwordx4 v[204:207], v6, s[40:43], s44 offen
    s_add_u32 s44, s44, 0x2000
    s_and_b32 s44, s44, 0x3ffff
    v_and_b32_dpp v20, v11, v12 row_newbcast:8 row_mask:0xf bank_mask:0xf
    v_and_b32_dpp v21, v11, v13 row_newbcast:8 row_mask:0xf bank_mask:0xf
    v_and_b32_dpp v22, v11, v14 row_newbcast:8 row_mask:0xf bank_mask:0xf
    v_and_b32_dpp v23, v11, v15 row_newbcast:8 row_mask:0xf bank_mask:0xf
    v_mfma_f32_16x16x32_bf16 v[24:27], v[16:19], v[192:195], v[24:27]
    s_waitcnt vmcnt(2)
    buffer_load_dwordx4 v[208:211], v6, s[40:43], s44 offen
    s_add_u32 s44, s44, 0x2000
    s_and_b32 s44, s44, 0x3ffff
    v_and_b32_dpp v16, v10, v12 row_newbcast:9 row_mask:0xf bank_mask:0xf
    v_and_b32_dpp v17, v10, v13 row_newbcast:9 row_mask:0xf bank_mask:0xf
    v_and_b32_dpp v18, v10, v14 row_newbcast:9 row_mask:0xf bank_mask:0xf
    v_and_b32_dpp v19, v10, v15 row_newbcast:9 row_mask:0xf bank_mask:0xf
    v_mfma_f32_16x16x32_bf16 v[24:27], v[20:23], v[196:199], v[24:27]
    s_waitcnt vmcnt(2)
    buffer_load_dwordx4 v[212:215], v6, s[40:43], s44 offen
    s_add_u32 s44, s44, 0x2000
    s_and_b32 s44, s44, 0x3ffff
    v_and_b32_dpp v20, v11, v12 row_newbcast:9 row_mask:0xf bank_mask:0xf
    v_and_b32_dpp v21, v11, v13 row_newbcast:9 row_mask:0xf bank_mask:0xf
    v_and_b32_dpp v22, v11, v14 row_newbcast:9 row_mask:0xf bank_mask:0xf
    v_and_b32_dpp v23, v11, v15 row_newbcast:9 row_mask:0xf bank_mask:0xf
    v_mfma_f32_16x16x32_bf16 v[24:27], v[16:19], v[200:203], v[24:27]
    s_waitcnt vmcnt(2)
    buffer_load_dwordx4 v[216:219], v6, s[40:43], s44 offen
    s_add_u32 s44, s44, 0x2000
    s_and_b32 s44, s44, 0x3ffff
    v_and_b32_dpp v16, v10, v12 row_newbcast:10 row_mask:0xf bank_mask:0xf
    v_and_b32_dpp v17, v10, v13 row_newbcast:10 row_mask:0xf bank_mask:0xf
    v_and_b32_dpp v18, v10, v14 row_newbcast:10 row_mask:0xf bank_mask:0xf
    v_and_b32_dpp v19, v10, v15 row_newbcast:10 row_mask:0xf bank_mask:0xf
    v_mfma_f32_16x16x32_bf16 v[24:27], v[20:23], v[204:207], v[24:27]
    s_waitcnt vmcnt(2)
    buffer_load_dwordx4 v[220:223], v6, s[40:43], s44 offen
    s_add_u32 s44, s44, 0x2000
    s_and_b32 s44, s44, 0x3ffff
    v_and_b32_dpp v20, v11, v12 row_newbcast:10 row_mask:0xf bank_mask:0xf
    v_and_b32_dpp v21, v11, v13 row_newbcast:10 row_mask:0xf bank_mask:0xf
    v_and_b32_dpp v22, v11, v14 row_newbcast:10 row_mask:0xf bank_mask:0xf
    v_and_b32_dpp v23, v11, v15 row_newbcast:10 row_mask:0xf bank_mask:0xf
    v_mfma_f32_16x16x32_bf16 v[24:27], v[16:19], v[208:211], v[24:27]
    s_waitcnt vmcnt(2)
    buffer_load_dwordx4 v[224:227], v6, s[40:43], s44 offen
    s_add_u32 s44, s44, 0x2000
    s_and_b32 s44, s44, 0x3ffff
    v_and_b32_dpp v16, v10, v12 row_newbcast:11 row_mask:0xf bank_mask:0xf
    v_and_b32_dpp v17, v10, v13 row_newbcast:11 row_mask:0xf bank_mask:0xf
    v_and_b32_dpp v18, v10, v14 row_newbcast:11 row_mask:0xf bank_mask:0xf
    v_and_b32_dpp v19, v10, v15 row_newbcast:11 row_mask:0xf bank_mask:0xf
    v_mfma_f32_16x16x32_bf16 v[24:27], v[20:23], v[212:215], v[24:27]
    s_waitcnt vmcnt(2)
    buffer_load_dwordx4 v[228:231], v6, s[40:43], s44 offen
    s_add_u32 s44, s44, 0x2000
    s_and_b32 s44, s44, 0x3ffff
    v_and_b32_dpp v20, v11, v12 row_newbcast:11 row_mask:0xf bank_mask:0xf
    v_and_b32_dpp v21, v11, v13 row_newbcast:11 row_mask:0xf bank_mask:0xf
    v_and_b32_dpp v22, v11, v14 row_newbcast:11 row_mask:0xf bank_mask:0xf
    v_and_b32_dpp v23, v11, v15 row_newbcast:11 row_mask:0xf bank_mask:0xf
    v_mfma_f32_16x16x32_bf16 v[24:27], v[16:19], v[216:219], v[24:27]
    s_waitcnt vmcnt(2)
    buffer_load_dwordx4 v[232:235], v6, s[40:43], s44 offen
    s_add_u32 s44, s44, 0x2000
    s_and_b32 s44, s44, 0x3ffff
    v_and_b32_dpp v16, v10, v12 row_newbcast:12 row_mask:0xf bank_mask:0xf
    v_and_b32_dpp v17, v10, v13 row_newbcast:12 row_mask:0xf bank_mask:0xf
    v_and_b32_dpp v18, v10, v14 row_newbcast:12 row_mask:0xf bank_mask:0xf
    v_and_b32_dpp v19, v10, v15 row_newbcast:12 row_mask:0xf bank_mask:0xf
    v_mfma_f32_16x16x32_bf16 v[24:27], v[20:23], v[220:223], v[24:27]
    s_waitcnt vmcnt(2)
    buffer_load_dwordx4 v[236:239], v6, s[40:43], s44 offen
    s_add_u32 s44, s44, 0x2000
    s_and_b32 s44, s44, 0x3ffff
    v_and_b32_dpp v20, v11, v12 row_newbcast:12 row_mask:0xf bank_mask:0xf
    v_and_b32_dpp v21, v11, v13 row_newbcast:12 row_mask:0xf bank_mask:0xf
    v_and_b32_dpp v22, v11, v14 row_newbcast:12 row_mask:0xf bank_mask:0xf
    v_and_b32_dpp v23, v11, v15 row_newbcast:12 row_mask:0xf bank_mask:0xf
    v_mfma_f32_16x16x32_bf16 v[24:27], v[16:19], v[224:227], v[24:27]
    s_waitcnt vmcnt(2)
    buffer_load_dwordx4 v[240:243], v6, s[40:43], s44 offen
    s_add_u32 s44, s44, 0x2000
    s_and_b32 s44, s44, 0x3ffff
    v_and_b32_dpp v16, v10, v12 row_newbcast:13 row_mask:0xf bank_mask:0xf
    v_and_b32_dpp v17, v10, v13 row_newbcast:13 row_mask:0xf bank_mask:0xf
    v_and_b32_dpp v18, v10, v14 row_newbcast:13 row_mask:0xf bank_mask:0xf
    v_and_b32_dpp v19, v10, v15 row_newbcast:13 row_mask:0xf bank_mask:0xf
    v_mfma_f32_16x16x32_bf16 v[24:27], v[20:23], v[228:231], v[24:27]
    s_waitcnt vmcnt(2)
    buffer_load_dwordx4 v[244:247], v6, s[40:43], s44 offen
    s_add_u32 s44, s44, 0x2000
    s_and_b32 s44, s44, 0x3ffff
    v_and_b32_dpp v20, v11, v12 row_newbcast:13 row_mask:0xf bank_mask:0xf
    v_and_b32_dpp v21, v11, v13 row_newbcast:13 row_mask:0xf bank_mask:0xf
    v_and_b32_dpp v22, v11, v14 row_newbcast:13 row_mask:0xf bank_mask:0xf
    v_and_b32_dpp v23, v11, v15 row_newbcast:13 row_mask:0xf bank_mask:0xf
    v_mfma_f32_16x16x32_bf16 v[24:27], v[16:19], v[232:235], v[24:27]
    s_waitcnt vmcnt(2)
    buffer_load_dwordx4 v[248:251], v6, s[40:43], s44 offen
    s_add_u32 s44, s44, 0x2000
    s_and_b32 s44, s44, 0x3ffff
    v_and_b32_dpp v16, v10, v12 row_newbcast:14 row_mask:0xf bank_mask:0xf
    v_and_b32_dpp v17, v10, v13 row_newbcast:14 row_mask:0xf bank_mask:0xf
    v_and_b32_dpp v18, v10, v14 row_newbcast:14 row_mask:0xf bank_mask:0xf
    v_and_b32_dpp v19, v10, v15 row_newbcast:14 row_mask:0xf bank_mask:0xf
    v_mfma_f32_16x16x32_bf16 v[24:27], v[20:23], v[236:239], v[24:27]
    s_waitcnt vmcnt(2)
    buffer_load_dwordx4 v[252:255], v6, s[40:43], s44 offen
    v_and_b32_dpp v20, v11, v12 row_newbcast:14 row_mask:0xf bank_mask:0xf
    v_and_b32_dpp v21, v11, v13 row_newbcast:14 row_mask:0xf bank_mask:0xf
    v_and_b32_dpp v22, v11, v14 row_newbcast:14 row_mask:0xf bank_mask:0xf
    v_and_b32_dpp v23, v11, v15 row_newbcast:14 row_mask:0xf bank_mask:0xf
    v_mfma_f32_16x16x32_bf16 v[24:27], v[16:19], v[240:243], v[24:27]
    s_waitcnt vmcnt(2)
    v_and_b32_dpp v16, v10, v12 row_newbcast:15 row_mask:0xf bank_mask:0xf
    v_and_b32_dpp v17, v10, v13 row_newbcast:15 row_mask:0xf bank_mask:0xf
    v_and_b32_dpp v18, v10, v14 row_newbcast:15 row_mask:0xf bank_mask:0xf
    v_and_b32_dpp v19, v10, v15 row_newbcast:15 row_mask:0xf bank_mask:0xf
    v_mfma_f32_16x16x32_bf16 v[24:27], v[20:23], v[244:247], v[24:27]
    s_waitcnt vmcnt(1)
    v_and_b32_dpp v20, v11, v12 row_newbcast:15 row_mask:0xf bank_mask:0xf
    v_and_b32_dpp v21, v11, v13 row_newbcast:15 row_mask:0xf bank_mask:0xf
    v_and_b32_dpp v22, v11, v14 row_newbcast:15 row_mask:0xf bank_mask:0xf
    v_and_b32_dpp v23, v11, v15 row_newbcast:15 row_mask:0xf bank_mask:0xf
    v_mfma_f32_16x16x32_bf16 v[24:27], v[16:19], v[248:251], v[24:27]
    s_waitcnt vmcnt(0)
    v_mfma_f32_16x16x32_bf16 v[24:27], v[20:23], v[252:255], v[24:27]
    v_lshlrev_b32 v8, 5, v2
    v_lshl_add_u32 v8, v1, 4, v8
    s_lshl_b32 s46, s35, 9
    v_add_u32 v8, s46, v8
    v_and_b32 v9, 3, v0
    v_lshlrev_b32 v9, 3, v9
    v_add_u32 v9, 4096, v9
    v_mov_b32 v10, -1
    v_mov_b32 v11, -1
    s_mov_b32 exec_hi, 0
    ds_write_b128 v8, v[24:27] offset:0
    s_mov_b32 exec_hi, -1
    s_waitcnt lgkmcnt(0)
    s_lshl_b32 s45, s35, 2
    v_mov_b32 v10, s45
    ds_write_b32 v10, v10 offset:4128
    s_add_u32 s74, s74, 1
    s_mov_b32 s75, 0xffffff00
    s_mov_b32 s62, 0x40000
    s_lshl_b32 s60, s30, 17
    s_add_u32 s48, s12, s60
    s_addc_u32 s49, s13, 0
    s_and_b32 s49, s49, 0xffff
    s_mov_b32 s50, 131072
    s_mov_b32 s51, 0x20000
    s_lshl_b32 s45, s35, 8
    v_lshlrev_b32 v37, 10, v1
    v_lshl_add_u32 v37, v2, 4, v37
    v_add_u32 v37, s45, v37
    s_lshl_b32 s34, s35, 13
    s_add_u32 s34, s34, 37376
    v_bfe_u32 v3, v0, 2, 2
    v_lshlrev_b32 v3, 8, v3
    v_lshl_add_u32 v3, v1, 10, v3
    v_and_b32 v4, 3, v0
    v_lshl_add_u32 v3, v4, 3, v3
    v_add_u32 v3, s34, v3
    v_lshlrev_b32 v4, 2, v0
    v_mov_b32 v10, 0
    ds_write_b32 v4, v10 offset:3136
    s_cmp_lg_u32 s35, 0
    s_cbranch_scc1 L_H123
    v_lshlrev_b32 v6, 10, v1
    v_bfe_u32 v7, v0, 2, 2
    v_lshl_add_u32 v6, v7, 7, v6
    v_and_b32 v7, 3, v0
    v_lshl_add_u32 v6, v7, 3, v6
    v_and_b32 v36, 1, v0
    v_lshlrev_b32 v36, 2, v36
    v_mul_u32_u24 v32, 37, v36
    v_add_u32 v32, s74, v32
    v_and_b32 v32, 0xff, v32
    v_mul_u32_u24 v33, 37, v36
    v_add_u32 v33, s74, v33
    v_add_u32 v33, 37, v33
    v_and_b32 v33, 0xff, v33
    v_mul_u32_u24 v34, 37, v36
    v_add_u32 v34, s74, v34
    v_add_u32 v34, 74, v34
    v_and_b32 v34, 0xff, v34
    v_mul_u32_u24 v35, 37, v36
    v_add_u32 v35, s74, v35
    v_add_u32 v35, 111, v35
    v_and_b32 v35, 0xff, v35
    v_lshrrev_b32 v38, 3, v0
    v_and_b32 v39, 7, v0
    s_cmp_ge_u32 s29, 7
    s_cbranch_scc1 L_notF1
    s_mul_i32 s45, s28, 7
    s_add_u32 s45, s45, s29
    s_lshr_b32 s46, s45, 1
    s_and_b32 s45, s45, 1
    s_cselect_b32 s56, s18, s16
    s_cselect_b32 s57, s19, s17
    s_lshl_b32 s60, s46, 7
    s_sub_u32 s61, 1835008, s60
    s_add_u32 s40, s56, s60
    s_addc_u32 s41, s57, 0
    s_and_b32 s41, s41, 0xffff
    s_mov_b32 s42, s61
    s_mov_b32 s43, 0x20000
    s_mul_i32 s45, s45, 28672
    s_lshl_b32 s46, s46, 10
    s_add_u32 s45, s45, s46
    s_add_u32 s45, s45, 1048576
    v_lshlrev_b32 v28, 10, v1
    v_lshl_add_u32 v28, v2, 4, v28
    buffer_load_dwordx4 v[40:43], v28, s[36:39], 0 offen offset:0
    buffer_load_dwordx4 v[44:47], v28, s[36:39], 0 offen offset:256
    buffer_load_dwordx4 v[48:51], v28, s[36:39], 0 offen offset:512
    buffer_load_dwordx4 v[52:55], v28, s[36:39], 0 offen offset:768
    v_mul_u32_u24 v4, 0xe00, v38
    v_lshl_add_u32 v4, v39, 4, v4
    s_mov_b32 s44, 0
    s_mov_b32 m0, 8704
    s_nop 0
    buffer_load_dwordx4 v4, s[40:43], s44 offen  lds
    s_mov_b32 s44, 28672
    s_mov_b32 m0, 9728
    s_nop 0
    buffer_load_dwordx4 v4, s[40:43], s44 offen  lds
    s_mov_b32 s44, 57344
    s_mov_b32 m0, 10752
    s_nop 0
    buffer_load_dwordx4 v4, s[40:43], s44 offen  lds
    s_mov_b32 s44, 86016
    s_mov_b32 m0, 11776
    s_nop 0
    buffer_load_dwordx4 v4, s[40:43], s44 offen  lds
    s_mov_b32 s44, 114688
    s_mov_b32 m0, 12800
    s_nop 0
    buffer_load_dwordx4 v4, s[40:43], s44 offen  lds
    s_mov_b32 s44, 143360
    s_mov_b32 m0, 13824
    s_nop 0
    buffer_load_dwordx4 v4, s[40:43], s44 offen  lds
    s_waitcnt vmcnt(5)
    s_mov_b32 s44, 172032
    s_mov_b32 m0, 14848
    s_nop 0
    buffer_load_dwordx4 v4, s[40:43], s44 offen  lds
    v_lshlrev_b32 v128, 16, v40
    v_and_b32 v129, 0xffff0000, v40
    v_lshlrev_b32 v130, 16, v41
    v_and_b32 v131, 0xffff0000, v41
    v_lshlrev_b32 v132, 16, v42
    v_and_b32 v133, 0xffff0000, v42
    v_lshlrev_b32 v134, 16, v43
    v_and_b32 v135, 0xffff0000, v43
    v_lshlrev_b32 v136, 16, v44
    v_and_b32 v137, 0xffff0000, v44
    v_lshlrev_b32 v138, 16, v45
    v_and_b32 v139, 0xffff0000, v45
    v_lshlrev_b32 v140, 16, v46
    v_and_b32 v141, 0xffff0000, v46
    v_lshlrev_b32 v142, 16, v47
    v_and_b32 v143, 0xffff0000, v47
    v_lshlrev_b32 v144, 16, v48
    v_and_b32 v145, 0xffff0000, v48
    v_lshlrev_b32 v146, 16, v49
    v_and_b32 v147, 0xffff0000, v49
    v_lshlrev_b32 v148, 16, v50
    v_and_b32 v149, 0xffff0000, v50
    v_lshlrev_b32 v150, 16, v51
    v_and_b32 v151, 0xffff0000, v51
    v_lshlrev_b32 v152, 16, v52
    v_and_b32 v153, 0xffff0000, v52
    v_lshlrev_b32 v154, 16, v53
    v_and_b32 v155, 0xffff0000, v53
    v_lshlrev_b32 v156, 16, v54
    v_and_b32 v157, 0xffff0000, v54
    v_lshlrev_b32 v158, 16, v55
    v_and_b32 v159, 0xffff0000, v55
    s_waitcnt vmcnt(5)
    s_mov_b32 s44, 200704
    s_mov_b32 m0, 15872
    s_nop 0
    buffer_load_dwordx4 v4, s[40:43], s44 offen  lds
    s_waitcnt vmcnt(5)
    s_mov_b32 s44, 229376
    s_mov_b32 m0, 16896
    s_nop 0
    buffer_load_dwordx4 v4, s[40:43], s44 offen  lds
    s_waitcnt vmcnt(5)
    s_mov_b32 s44, 258048
    s_mov_b32 m0, 17920
    s_nop 0
    buffer_load_dwordx4 v4, s[40:43], s44 offen  lds
    s_waitcnt vmcnt(5)
    s_mov_b32 s44, 286720
    s_mov_b32 m0, 18944
    s_nop 0
    buffer_load_dwordx4 v4, s[40:43], s44 offen  lds
    s_waitcnt vmcnt(5)
    s_mov_b32 s44, 315392
    s_mov_b32 m0, 19968
    s_nop 0
    buffer_load_dwordx4 v4, s[40:43], s44 offen  lds
    v_add_f32 v24, v128, v129
    v_add_f32 v25, v130, v131
    v_add_f32 v24, v24, v132
    v_add_f32 v25, v25, v133
    v_add_f32 v24, v24, v134
    v_add_f32 v25, v25, v135
    v_add_f32 v24, v24, v136
    v_add_f32 v25, v25, v137
    v_add_f32 v24, v24, v138
    v_add_f32 v25, v25, v139
    v_add_f32 v24, v24, v140
    v_add_f32 v25, v25, v141
    v_add_f32 v24, v24, v142
    v_add_f32 v25, v25, v143
    v_add_f32 v24, v24, v144
    v_add_f32 v25, v25, v145
    v_add_f32 v24, v24, v146
    v_add_f32 v25, v25, v147
    v_add_f32 v24, v24, v148
    v_add_f32 v25, v25, v149
    v_add_f32 v24, v24, v150
    v_add_f32 v25, v25, v151
    v_add_f32 v24, v24, v152
    v_add_f32 v25, v25, v153
    v_add_f32 v24, v24, v154
    v_add_f32 v25, v25, v155
    v_add_f32 v24, v24, v156
    v_add_f32 v25, v25, v157
    v_add_f32 v24, v24, v158
    v_add_f32 v25, v25, v159
    v_add_f32 v24, v24, v25
    s_nop 1
    v_add_f32_dpp v24, v24, v24 quad_perm:[1,0,3,2] row_mask:0xf bank_mask:0xf
    s_nop 1
    v_add_f32_dpp v24, v24, v24 quad_perm:[2,3,0,1] row_mask:0xf bank_mask:0xf
    s_nop 1
    v_add_f32_dpp v24, v24, v24 row_half_mirror row_mask:0xf bank_mask:0xf
    s_nop 1
    v_add_f32_dpp v24, v24, v24 row_mirror row_mask:0xf bank_mask:0xf
    v_mul_f32 v24, 0x3b000000, v24
    v_mov_b32 v25, 0
    v_mov_b32 v26, 0
    v_sub_f32 v27, v128, v24
    v_fmac_f32 v25, v27, v27
    v_sub_f32 v27, v129, v24
    v_fmac_f32 v26, v27, v27
    v_sub_f32 v27, v130, v24
    v_fmac_f32 v25, v27, v27
    v_sub_f32 v27, v131, v24
    v_fmac_f32 v26, v27, v27
    v_sub_f32 v27, v132, v24
    v_fmac_f32 v25, v27, v27
    v_sub_f32 v27, v133, v24
    v_fmac_f32 v26, v27, v27
    v_sub_f32 v27, v134, v24
    v_fmac_f32 v25, v27, v27
    v_sub_f32 v27, v135, v24
    v_fmac_f32 v26, v27, v27
    v_sub_f32 v27, v136, v24
    v_fmac_f32 v25, v27, v27
    v_sub_f32 v27, v137, v24
    v_fmac_f32 v26, v27, v27
    v_sub_f32 v27, v138, v24
    v_fmac_f32 v25, v27, v27
    v_sub_f32 v27, v139, v24
    v_fmac_f32 v26, v27, v27
    v_sub_f32 v27, v140, v24
    v_fmac_f32 v25, v27, v27
    v_sub_f32 v27, v141, v24
    v_fmac_f32 v26, v27, v27
    v_sub_f32 v27, v142, v24
    v_fmac_f32 v25, v27, v27
    v_sub_f32 v27, v143, v24
    v_fmac_f32 v26, v27, v27
    v_sub_f32 v27, v144, v24
    v_fmac_f32 v25, v27, v27
    v_sub_f32 v27, v145, v24
    v_fmac_f32 v26, v27, v27
    v_sub_f32 v27, v146, v24
    v_fmac_f32 v25, v27, v27
    v_sub_f32 v27, v147, v24
    v_fmac_f32 v26, v27, v27
    v_sub_f32 v27, v148, v24
    v_fmac_f32 v25, v27, v27
    v_sub_f32 v27, v149, v24
    v_fmac_f32 v26, v27, v27
    v_sub_f32 v27, v150, v24
    v_fmac_f32 v25, v27, v27
    v_sub_f32 v27, v151, v24
    v_fmac_f32 v26, v27, v27
    v_sub_f32 v27, v152, v24
    v_fmac_f32 v25, v27, v27
    v_sub_f32 v27, v153, v24
    v_fmac_f32 v26, v27, v27
    v_sub_f32 v27, v154, v24
    v_fmac_f32 v25, v27, v27
    v_sub_f32 v27, v155, v24
    v_fmac_f32 v26, v27, v27
    v_sub_f32 v27, v156, v24
    v_fmac_f32 v25, v27, v27
    v_sub_f32 v27, v157, v24
    v_fmac_f32 v26, v27, v27
    v_sub_f32 v27, v158, v24
    v_fmac_f32 v25, v27, v27
    v_sub_f32 v27, v159, v24
    v_fmac_f32 v26, v27, v27
    v_add_f32 v25, v25, v26
    s_nop 1
    v_add_f32_dpp v25, v25, v25 quad_perm:[1,0,3,2] row_mask:0xf bank_mask:0xf
    s_nop 1
    v_add_f32_dpp v25, v25, v25 quad_perm:[2,3,0,1] row_mask:0xf bank_mask:0xf
    s_nop 1
    v_add_f32_dpp v25, v25, v25 row_half_mirror row_mask:0xf bank_mask:0xf
    s_nop 1
    v_add_f32_dpp v25, v25, v25 row_mirror row_mask:0xf bank_mask:0xf
    v_mul_f32 v25, 0x3b000000, v25
    v_cvt_pk_bf16_f32 v24, 0, v24
    v_cvt_pk_bf16_f32 v25, 0, v25
    v_add_f32 v25, 0x37280000, v25
    v_cvt_pk_bf16_f32 v25, 0, v25
    v_sqrt_f32 v25, v25
    s_nop 0
    v_cvt_pk_bf16_f32 v25, 0, v25
    v_rcp_f32 v25, v25
    v_sub_f32 v128, v128, v24
    v_cvt_pk_bf16_f32 v128, 0, v128
    v_mul_f32 v128, v128, v25
    v_sub_f32 v129, v129, v24
    v_cvt_pk_bf16_f32 v129, 0, v129
    v_mul_f32 v129, v129, v25
    v_sub_f32 v130, v130, v24
    v_cvt_pk_bf16_f32 v130, 0, v130
    v_mul_f32 v130, v130, v25
    v_sub_f32 v131, v131, v24
    v_cvt_pk_bf16_f32 v131, 0, v131
    v_mul_f32 v131, v131, v25
    v_sub_f32 v132, v132, v24
    v_cvt_pk_bf16_f32 v132, 0, v132
    v_mul_f32 v132, v132, v25
    v_sub_f32 v133, v133, v24
    v_cvt_pk_bf16_f32 v133, 0, v133
    v_mul_f32 v133, v133, v25
    v_sub_f32 v134, v134, v24
    v_cvt_pk_bf16_f32 v134, 0, v134
    v_mul_f32 v134, v134, v25
    v_sub_f32 v135, v135, v24
    v_cvt_pk_bf16_f32 v135, 0, v135
    v_mul_f32 v135, v135, v25
    v_sub_f32 v136, v136, v24
    v_cvt_pk_bf16_f32 v136, 0, v136
    v_mul_f32 v136, v136, v25
    v_sub_f32 v137, v137, v24
    v_cvt_pk_bf16_f32 v137, 0, v137
    v_mul_f32 v137, v137, v25
    v_sub_f32 v138, v138, v24
    v_cvt_pk_bf16_f32 v138, 0, v138
    v_mul_f32 v138, v138, v25
    v_sub_f32 v139, v139, v24
    v_cvt_pk_bf16_f32 v139, 0, v139
    v_mul_f32 v139, v139, v25
    v_sub_f32 v140, v140, v24
    v_cvt_pk_bf16_f32 v140, 0, v140
    v_mul_f32 v140, v140, v25
    v_sub_f32 v141, v141, v24
    v_cvt_pk_bf16_f32 v141, 0, v141
    v_mul_f32 v141, v141, v25
    v_sub_f32 v142, v142, v24
    v_cvt_pk_bf16_f32 v142, 0, v142
    v_mul_f32 v142, v142, v25
    v_sub_f32 v143, v143, v24
    v_cvt_pk_bf16_f32 v143, 0, v143
    v_mul_f32 v143, v143, v25
    v_sub_f32 v144, v144, v24
    v_cvt_pk_bf16_f32 v144, 0, v144
    v_mul_f32 v144, v144, v25
    v_sub_f32 v145, v145, v24
    v_cvt_pk_bf16_f32 v145, 0, v145
    v_mul_f32 v145, v145, v25
    v_sub_f32 v146, v146, v24
    v_cvt_pk_bf16_f32 v146, 0, v146
    v_mul_f32 v146, v146, v25
    v_sub_f32 v147, v147, v24
    v_cvt_pk_bf16_f32 v147, 0, v147
    v_mul_f32 v147, v147, v25
    v_sub_f32 v148, v148, v24
    v_cvt_pk_bf16_f32 v148, 0, v148
    v_mul_f32 v148, v148, v25
    v_sub_f32 v149, v149, v24
    v_cvt_pk_bf16_f32 v149, 0, v149
    v_mul_f32 v149, v149, v25
    v_sub_f32 v150, v150, v24
    v_cvt_pk_bf16_f32 v150, 0, v150
    v_mul_f32 v150, v150, v25
    v_sub_f32 v151, v151, v24
    v_cvt_pk_bf16_f32 v151, 0, v151
    v_mul_f32 v151, v151, v25
    v_sub_f32 v152, v152, v24
    v_cvt_pk_bf16_f32 v152, 0, v152
    v_mul_f32 v152, v152, v25
    v_sub_f32 v153, v153, v24
    v_cvt_pk_bf16_f32 v153, 0, v153
    v_mul_f32 v153, v153, v25
    v_sub_f32 v154, v154, v24
    v_cvt_pk_bf16_f32 v154, 0, v154
    v_mul_f32 v154, v154, v25
    v_sub_f32 v155, v155, v24
    v_cvt_pk_bf16_f32 v155, 0, v155
    v_mul_f32 v155, v155, v25
    v_sub_f32 v156, v156, v24
    v_cvt_pk_bf16_f32 v156, 0, v156
    v_mul_f32 v156, v156, v25
    v_sub_f32 v157, v157, v24
    v_cvt_pk_bf16_f32 v157, 0, v157
    v_mul_f32 v157, v157, v25
    v_sub_f32 v158, v158, v24
    v_cvt_pk_bf16_f32 v158, 0, v158
    v_mul_f32 v158, v158, v25
    v_sub_f32 v159, v159, v24
    v_cvt_pk_bf16_f32 v159, 0, v159
    v_mul_f32 v159, v159, v25
    v_cvt_pk_bf16_f32 v40, v128, v129
    v_cvt_pk_bf16_f32 v41, v130, v131
    v_cvt_pk_bf16_f32 v42, v132, v133
    v_cvt_pk_bf16_f32 v43, v134, v135
    v_cvt_pk_bf16_f32 v44, v136, v137
    v_cvt_pk_bf16_f32 v45, v138, v139
    v_cvt_pk_bf16_f32 v46, v140, v141
    v_cvt_pk_bf16_f32 v47, v142, v143
    v_cvt_pk_bf16_f32 v48, v144, v145
    v_cvt_pk_bf16_f32 v49, v146, v147
    v_cvt_pk_bf16_f32 v50, v148, v149
    v_cvt_pk_bf16_f32 v51, v150, v151
    v_cvt_pk_bf16_f32 v52, v152, v153
    v_cvt_pk_bf16_f32 v53, v154, v155
    v_cvt_pk_bf16_f32 v54, v156, v157
    v_cvt_pk_bf16_f32 v55, v158, v159
    ds_write_b128 v28, v[40:43] offset:4608
    ds_write_b128 v28, v[44:47] offset:4864
    ds_write_b128 v28, v[48:51] offset:5120
    ds_write_b128 v28, v[52:55] offset:5376
    v_lshlrev_b32 v7, 10, v7
    v_lshl_add_u32 v7, v1, 4, v7
    ds_read_b64_tr_b16 v[56:57], v6 offset:8704
    ds_read_b64_tr_b16 v[58:59], v6 offset:9216
    ds_read_b64_tr_b16 v[60:61], v6 offset:8736
    ds_read_b64_tr_b16 v[62:63], v6 offset:9248
    ds_read_b64_tr_b16 v[64:65], v6 offset:8768
    ds_read_b64_tr_b16 v[66:67], v6 offset:9280
    ds_read_b64_tr_b16 v[68:69], v6 offset:8800
    ds_read_b64_tr_b16 v[70:71], v6 offset:9312
    ds_read_b128 v[72:75], v7 offset:4608
    s_waitcnt lgkmcnt(0)
    v_mfma_f32_16x16x32_bf16 v[96:99], v[72:75], v[56:59], 0
    v_mfma_f32_16x16x32_bf16 v[100:103], v[72:75], v[60:63], 0
    v_mfma_f32_16x16x32_bf16 v[104:107], v[72:75], v[64:67], 0
    v_mfma_f32_16x16x32_bf16 v[108:111], v[72:75], v[68:71], 0
    s_nop 3
    s_waitcnt vmcnt(5)
    s_mov_b32 s44, 344064
    s_mov_b32 m0, 20992
    s_nop 0
    buffer_load_dwordx4 v4, s[40:43], s44 offen  lds
    s_waitcnt vmcnt(5)
    s_mov_b32 s44, 372736
    s_mov_b32 m0, 22016
    s_nop 0
    buffer_load_dwordx4 v4, s[40:43], s44 offen  lds
    ds_read_b64_tr_b16 v[56:57], v6 offset:12800
    ds_read_b64_tr_b16 v[58:59], v6 offset:13312
    ds_read_b64_tr_b16 v[60:61], v6 offset:12832
    ds_read_b64_tr_b16 v[62:63], v6 offset:13344
    ds_read_b64_tr_b16 v[64:65], v6 offset:12864
    ds_read_b64_tr_b16 v[66:67], v6 offset:13376
    ds_read_b64_tr_b16 v[68:69], v6 offset:12896
    ds_read_b64_tr_b16 v[70:71], v6 offset:13408
    ds_read_b128 v[72:75], v7 offset:4672
    s_waitcnt lgkmcnt(0)
    v_mfma_f32_16x16x32_bf16 v[96:99], v[72:75], v[56:59], v[96:99]
    v_mfma_f32_16x16x32_bf16 v[100:103], v[72:75], v[60:63], v[100:103]
    v_mfma_f32_16x16x32_bf16 v[104:107], v[72:75], v[64:67], v[104:107]
    v_mfma_f32_16x16x32_bf16 v[108:111], v[72:75], v[68:71], v[108:111]
    s_nop 3
    s_waitcnt vmcnt(5)
    s_mov_b32 s44, 401408
    s_mov_b32 m0, 23040
    s_nop 0
    buffer_load_dwordx4 v4, s[40:43], s44 offen  lds
    s_waitcnt vmcnt(5)
    s_mov_b32 s44, 430080
    s_mov_b32 m0, 24064
    s_nop 0
    buffer_load_dwordx4 v4, s[40:43], s44 offen  lds
    s_waitcnt vmcnt(5)
    s_mov_b32 s44, 458752
    s_mov_b32 m0, 25088
    s_nop 0
    buffer_load_dwordx4 v4, s[40:43], s44 offen  lds
    s_waitcnt vmcnt(5)
    s_mov_b32 s44, 487424
    s_mov_b32 m0, 26112
    s_nop 0
    buffer_load_dwordx4 v4, s[40:43], s44 offen  lds
    ds_read_b64_tr_b16 v[56:57], v6 offset:16896
    ds_read_b64_tr_b16 v[58:59], v6 offset:17408
    ds_read_b64_tr_b16 v[60:61], v6 offset:16928
    ds_read_b64_tr_b16 v[62:63], v6 offset:17440
    ds_read_b64_tr_b16 v[64:65], v6 offset:16960
    ds_read_b64_tr_b16 v[66:67], v6 offset:17472
    ds_read_b64_tr_b16 v[68:69], v6 offset:16992
    ds_read_b64_tr_b16 v[70:71], v6 offset:17504
    ds_read_b128 v[72:75], v7 offset:4736
    s_waitcnt lgkmcnt(0)
    v_mfma_f32_16x16x32_bf16 v[96:99], v[72:75], v[56:59], v[96:99]
    v_mfma_f32_16x16x32_bf16 v[100:103], v[72:75], v[60:63], v[100:103]
    v_mfma_f32_16x16x32_bf16 v[104:107], v[72:75], v[64:67], v[104:107]
    v_mfma_f32_16x16x32_bf16 v[108:111], v[72:75], v[68:71], v[108:111]
    s_nop 3
    s_waitcnt vmcnt(5)
    s_mov_b32 s44, 516096
    s_mov_b32 m0, 27136
    s_nop 0
    buffer_load_dwordx4 v4, s[40:43], s44 offen  lds
    s_waitcnt vmcnt(5)
    s_mov_b32 s44, 544768
    s_mov_b32 m0, 28160
    s_nop 0
    buffer_load_dwordx4 v4, s[40:43], s44 offen  lds
    s_waitcnt vmcnt(5)
    s_mov_b32 s44, 573440
    s_mov_b32 m0, 29184
    s_nop 0
    buffer_load_dwordx4 v4, s[40:43], s44 offen  lds
    s_waitcnt vmcnt(5)
    s_mov_b32 s44, 602112
    s_mov_b32 m0, 30208
    s_nop 0
    buffer_load_dwordx4 v4, s[40:43], s44 offen  lds
    ds_read_b64_tr_b16 v[56:57], v6 offset:20992
    ds_read_b64_tr_b16 v[58:59], v6 offset:21504
    ds_read_b64_tr_b16 v[60:61], v6 offset:21024
    ds_read_b64_tr_b16 v[62:63], v6 offset:21536
    ds_read_b64_tr_b16 v[64:65], v6 offset:21056
    ds_read_b64_tr_b16 v[66:67], v6 offset:21568
    ds_read_b64_tr_b16 v[68:69], v6 offset:21088
    ds_read_b64_tr_b16 v[70:71], v6 offset:21600
    ds_read_b128 v[72:75], v7 offset:4800
    s_waitcnt lgkmcnt(0)
    v_mfma_f32_16x16x32_bf16 v[96:99], v[72:75], v[56:59], v[96:99]
    v_mfma_f32_16x16x32_bf16 v[100:103], v[72:75], v[60:63], v[100:103]
    v_mfma_f32_16x16x32_bf16 v[104:107], v[72:75], v[64:67], v[104:107]
    v_mfma_f32_16x16x32_bf16 v[108:111], v[72:75], v[68:71], v[108:111]
    s_nop 3
    s_waitcnt vmcnt(5)
    s_mov_b32 s44, 630784
    s_mov_b32 m0, 31232
    s_nop 0
    buffer_load_dwordx4 v4, s[40:43], s44 offen  lds
    s_waitcnt vmcnt(5)
    s_mov_b32 s44, 659456
    s_mov_b32 m0, 32256
    s_nop 0
    buffer_load_dwordx4 v4, s[40:43], s44 offen  lds
    s_waitcnt vmcnt(5)
    s_mov_b32 s44, 688128
    s_mov_b32 m0, 33280
    s_nop 0
    buffer_load_dwordx4 v4, s[40:43], s44 offen  lds
    s_waitcnt vmcnt(5)
    s_mov_b32 s44, 716800
    s_mov_b32 m0, 34304
    s_nop 0
    buffer_load_dwordx4 v4, s[40:43], s44 offen  lds
    ds_read_b64_tr_b16 v[56:57], v6 offset:25088
    ds_read_b64_tr_b16 v[58:59], v6 offset:25600
    ds_read_b64_tr_b16 v[60:61], v6 offset:25120
    ds_read_b64_tr_b16 v[62:63], v6 offset:25632
    ds_read_b64_tr_b16 v[64:65], v6 offset:25152
    ds_read_b64_tr_b16 v[66:67], v6 offset:25664
    ds_read_b64_tr_b16 v[68:69], v6 offset:25184
    ds_read_b64_tr_b16 v[70:71], v6 offset:25696
    ds_read_b128 v[72:75], v7 offset:4864
    s_waitcnt lgkmcnt(0)
    v_mfma_f32_16x16x32_bf16 v[96:99], v[72:75], v[56:59], v[96:99]
    v_mfma_f32_16x16x32_bf16 v[100:103], v[72:75], v[60:63], v[100:103]
    v_mfma_f32_16x16x32_bf16 v[104:107], v[72:75], v[64:67], v[104:107]
    v_mfma_f32_16x16x32_bf16 v[108:111], v[72:75], v[68:71], v[108:111]
    s_nop 3
    s_waitcnt vmcnt(5)
    s_mov_b32 s44, 745472
    s_mov_b32 m0, 35328
    s_nop 0
    buffer_load_dwordx4 v4, s[40:43], s44 offen  lds
    s_waitcnt vmcnt(5)
    s_mov_b32 s44, 774144
    s_mov_b32 m0, 36352
    s_nop 0
    buffer_load_dwordx4 v4, s[40:43], s44 offen  lds
    s_waitcnt vmcnt(5)
    s_mov_b32 s44, 802816
    s_mov_b32 m0, 8704
    s_nop 0
    buffer_load_dwordx4 v4, s[40:43], s44 offen  lds
    s_waitcnt vmcnt(5)
    s_mov_b32 s44, 831488
    s_mov_b32 m0, 9728
    s_nop 0
    buffer_load_dwordx4 v4, s[40:43], s44 offen  lds
    ds_read_b64_tr_b16 v[56:57], v6 offset:29184
    ds_read_b64_tr_b16 v[58:59], v6 offset:29696
    ds_read_b64_tr_b16 v[60:61], v6 offset:29216
    ds_read_b64_tr_b16 v[62:63], v6 offset:29728
    ds_read_b64_tr_b16 v[64:65], v6 offset:29248
    ds_read_b64_tr_b16 v[66:67], v6 offset:29760
    ds_read_b64_tr_b16 v[68:69], v6 offset:29280
    ds_read_b64_tr_b16 v[70:71], v6 offset:29792
    ds_read_b128 v[72:75], v7 offset:4928
    s_waitcnt lgkmcnt(0)
    v_mfma_f32_16x16x32_bf16 v[96:99], v[72:75], v[56:59], v[96:99]
    v_mfma_f32_16x16x32_bf16 v[100:103], v[72:75], v[60:63], v[100:103]
    v_mfma_f32_16x16x32_bf16 v[104:107], v[72:75], v[64:67], v[104:107]
    v_mfma_f32_16x16x32_bf16 v[108:111], v[72:75], v[68:71], v[108:111]
    s_nop 3
    s_waitcnt vmcnt(5)
    s_mov_b32 s44, 860160
    s_mov_b32 m0, 10752
    s_nop 0
    buffer_load_dwordx4 v4, s[40:43], s44 offen  lds
    s_waitcnt vmcnt(5)
    s_mov_b32 s44, 888832
    s_mov_b32 m0, 11776
    s_nop 0
    buffer_load_dwordx4 v4, s[40:43], s44 offen  lds
    s_waitcnt vmcnt(5)
    s_mov_b32 s44, 917504
    s_mov_b32 m0, 12800
    s_nop 0
    buffer_load_dwordx4 v4, s[40:43], s44 offen  lds
    s_waitcnt vmcnt(5)
    s_mov_b32 s44, 946176
    s_mov_b32 m0, 13824
    s_nop 0
    buffer_load_dwordx4 v4, s[40:43], s44 offen  lds
    ds_read_b64_tr_b16 v[56:57], v6 offset:33280
    ds_read_b64_tr_b16 v[58:59], v6 offset:33792
    ds_read_b64_tr_b16 v[60:61], v6 offset:33312
    ds_read_b64_tr_b16 v[62:63], v6 offset:33824
    ds_read_b64_tr_b16 v[64:65], v6 offset:33344
    ds_read_b64_tr_b16 v[66:67], v6 offset:33856
    ds_read_b64_tr_b16 v[68:69], v6 offset:33376
    ds_read_b64_tr_b16 v[70:71], v6 offset:33888
    ds_read_b128 v[72:75], v7 offset:4992
    s_waitcnt lgkmcnt(0)
    v_mfma_f32_16x16x32_bf16 v[96:99], v[72:75], v[56:59], v[96:99]
    v_mfma_f32_16x16x32_bf16 v[100:103], v[72:75], v[60:63], v[100:103]
    v_mfma_f32_16x16x32_bf16 v[104:107], v[72:75], v[64:67], v[104:107]
    v_mfma_f32_16x16x32_bf16 v[108:111], v[72:75], v[68:71], v[108:111]
    s_nop 3
    s_waitcnt vmcnt(5)
    s_mov_b32 s44, 974848
    s_mov_b32 m0, 14848
    s_nop 0
    buffer_load_dwordx4 v4, s[40:43], s44 offen  lds
    s_waitcnt vmcnt(5)
    s_mov_b32 s44, 1003520
    s_mov_b32 m0, 15872
    s_nop 0
    buffer_load_dwordx4 v4, s[40:43], s44 offen  lds
    s_waitcnt vmcnt(5)
    s_mov_b32 s44, 1032192
    s_mov_b32 m0, 16896
    s_nop 0
    buffer_load_dwordx4 v4, s[40:43], s44 offen  lds
    s_waitcnt vmcnt(5)
    s_mov_b32 s44, 1060864
    s_mov_b32 m0, 17920
    s_nop 0
    buffer_load_dwordx4 v4, s[40:43], s44 offen  lds
    ds_read_b64_tr_b16 v[56:57], v6 offset:8704
    ds_read_b64_tr_b16 v[58:59], v6 offset:9216
    ds_read_b64_tr_b16 v[60:61], v6 offset:8736
    ds_read_b64_tr_b16 v[62:63], v6 offset:9248
    ds_read_b64_tr_b16 v[64:65], v6 offset:8768
    ds_read_b64_tr_b16 v[66:67], v6 offset:9280
    ds_read_b64_tr_b16 v[68:69], v6 offset:8800
    ds_read_b64_tr_b16 v[70:71], v6 offset:9312
    ds_read_b128 v[72:75], v7 offset:5056
    s_waitcnt lgkmcnt(0)
    v_mfma_f32_16x16x32_bf16 v[96:99], v[72:75], v[56:59], v[96:99]
    v_mfma_f32_16x16x32_bf16 v[100:103], v[72:75], v[60:63], v[100:103]
    v_mfma_f32_16x16x32_bf16 v[104:107], v[72:75], v[64:67], v[104:107]
    v_mfma_f32_16x16x32_bf16 v[108:111], v[72:75], v[68:71], v[108:111]
    s_nop 3
    s_waitcnt vmcnt(5)
    s_mov_b32 s44, 1089536
    s_mov_b32 m0, 18944
    s_nop 0
    buffer_load_dwordx4 v4, s[40:43], s44 offen  lds
    s_waitcnt vmcnt(5)
    s_mov_b32 s44, 1118208
    s_mov_b32 m0, 19968
    s_nop 0
    buffer_load_dwordx4 v4, s[40:43], s44 offen  lds
    s_waitcnt vmcnt(5)
    s_mov_b32 s44, 1146880
    s_mov_b32 m0, 20992
    s_nop 0
    buffer_load_dwordx4 v4, s[40:43], s44 offen  lds
    s_waitcnt vmcnt(5)
    s_mov_b32 s44, 1175552
    s_mov_b32 m0, 22016
    s_nop 0
    buffer_load_dwordx4 v4, s[40:43], s44 offen  lds
    ds_read_b64_tr_b16 v[56:57], v6 offset:12800
    ds_read_b64_tr_b16 v[58:59], v6 offset:13312
    ds_read_b64_tr_b16 v[60:61], v6 offset:12832
    ds_read_b64_tr_b16 v[62:63], v6 offset:13344
    ds_read_b64_tr_b16 v[64:65], v6 offset:12864
    ds_read_b64_tr_b16 v[66:67], v6 offset:13376
    ds_read_b64_tr_b16 v[68:69], v6 offset:12896
    ds_read_b64_tr_b16 v[70:71], v6 offset:13408
    ds_read_b128 v[72:75], v7 offset:5120
    s_waitcnt lgkmcnt(0)
    v_mfma_f32_16x16x32_bf16 v[96:99], v[72:75], v[56:59], v[96:99]
    v_mfma_f32_16x16x32_bf16 v[100:103], v[72:75], v[60:63], v[100:103]
    v_mfma_f32_16x16x32_bf16 v[104:107], v[72:75], v[64:67], v[104:107]
    v_mfma_f32_16x16x32_bf16 v[108:111], v[72:75], v[68:71], v[108:111]
    s_nop 3
    s_waitcnt vmcnt(5)
    s_mov_b32 s44, 1204224
    s_mov_b32 m0, 23040
    s_nop 0
    buffer_load_dwordx4 v4, s[40:43], s44 offen  lds
    s_waitcnt vmcnt(5)
    s_mov_b32 s44, 1232896
    s_mov_b32 m0, 24064
    s_nop 0
    buffer_load_dwordx4 v4, s[40:43], s44 offen  lds
    s_waitcnt vmcnt(5)
    s_mov_b32 s44, 1261568
    s_mov_b32 m0, 25088
    s_nop 0
    buffer_load_dwordx4 v4, s[40:43], s44 offen  lds
    s_waitcnt vmcnt(5)
    s_mov_b32 s44, 1290240
    s_mov_b32 m0, 26112
    s_nop 0
    buffer_load_dwordx4 v4, s[40:43], s44 offen  lds
    ds_read_b64_tr_b16 v[56:57], v6 offset:16896
    ds_read_b64_tr_b16 v[58:59], v6 offset:17408
    ds_read_b64_tr_b16 v[60:61], v6 offset:16928
    ds_read_b64_tr_b16 v[62:63], v6 offset:17440
    ds_read_b64_tr_b16 v[64:65], v6 offset:16960
    ds_read_b64_tr_b16 v[66:67], v6 offset:17472
    ds_read_b64_tr_b16 v[68:69], v6 offset:16992
    ds_read_b64_tr_b16 v[70:71], v6 offset:17504
    ds_read_b128 v[72:75], v7 offset:5184
    s_waitcnt lgkmcnt(0)
    v_mfma_f32_16x16x32_bf16 v[96:99], v[72:75], v[56:59], v[96:99]
    v_mfma_f32_16x16x32_bf16 v[100:103], v[72:75], v[60:63], v[100:103]
    v_mfma_f32_16x16x32_bf16 v[104:107], v[72:75], v[64:67], v[104:107]
    v_mfma_f32_16x16x32_bf16 v[108:111], v[72:75], v[68:71], v[108:111]
    s_nop 3
    s_waitcnt vmcnt(5)
    s_mov_b32 s44, 1318912
    s_mov_b32 m0, 27136
    s_nop 0
    buffer_load_dwordx4 v4, s[40:43], s44 offen  lds
    s_waitcnt vmcnt(5)
    s_mov_b32 s44, 1347584
    s_mov_b32 m0, 28160
    s_nop 0
    buffer_load_dwordx4 v4, s[40:43], s44 offen  lds
    s_waitcnt vmcnt(5)
    s_mov_b32 s44, 1376256
    s_mov_b32 m0, 29184
    s_nop 0
    buffer_load_dwordx4 v4, s[40:43], s44 offen  lds
    s_waitcnt vmcnt(5)
    s_mov_b32 s44, 1404928
    s_mov_b32 m0, 30208
    s_nop 0
    buffer_load_dwordx4 v4, s[40:43], s44 offen  lds
    ds_read_b64_tr_b16 v[56:57], v6 offset:20992
    ds_read_b64_tr_b16 v[58:59], v6 offset:21504
    ds_read_b64_tr_b16 v[60:61], v6 offset:21024
    ds_read_b64_tr_b16 v[62:63], v6 offset:21536
    ds_read_b64_tr_b16 v[64:65], v6 offset:21056
    ds_read_b64_tr_b16 v[66:67], v6 offset:21568
    ds_read_b64_tr_b16 v[68:69], v6 offset:21088
    ds_read_b64_tr_b16 v[70:71], v6 offset:21600
    ds_read_b128 v[72:75], v7 offset:5248
    s_waitcnt lgkmcnt(0)
    v_mfma_f32_16x16x32_bf16 v[96:99], v[72:75], v[56:59], v[96:99]
    v_mfma_f32_16x16x32_bf16 v[100:103], v[72:75], v[60:63], v[100:103]
    v_mfma_f32_16x16x32_bf16 v[104:107], v[72:75], v[64:67], v[104:107]
    v_mfma_f32_16x16x32_bf16 v[108:111], v[72:75], v[68:71], v[108:111]
    s_nop 3
    s_waitcnt vmcnt(5)
    s_mov_b32 s44, 1433600
    s_mov_b32 m0, 31232
    s_nop 0
    buffer_load_dwordx4 v4, s[40:43], s44 offen  lds
    s_waitcnt vmcnt(5)
    s_mov_b32 s44, 1462272
    s_mov_b32 m0, 32256
    s_nop 0
    buffer_load_dwordx4 v4, s[40:43], s44 offen  lds
    s_waitcnt vmcnt(5)
    s_mov_b32 s44, 1490944
    s_mov_b32 m0, 33280
    s_nop 0
    buffer_load_dwordx4 v4, s[40:43], s44 offen  lds
    s_waitcnt vmcnt(5)
    s_mov_b32 s44, 1519616
    s_mov_b32 m0, 34304
    s_nop 0
    buffer_load_dwordx4 v4, s[40:43], s44 offen  lds
    ds_read_b64_tr_b16 v[56:57], v6 offset:25088
    ds_read_b64_tr_b16 v[58:59], v6 offset:25600
    ds_read_b64_tr_b16 v[60:61], v6 offset:25120
    ds_read_b64_tr_b16 v[62:63], v6 offset:25632
    ds_read_b64_tr_b16 v[64:65], v6 offset:25152
    ds_read_b64_tr_b16 v[66:67], v6 offset:25664
    ds_read_b64_tr_b16 v[68:69], v6 offset:25184
    ds_read_b64_tr_b16 v[70:71], v6 offset:25696
    ds_read_b128 v[72:75], v7 offset:5312
    s_waitcnt lgkmcnt(0)
    v_mfma_f32_16x16x32_bf16 v[96:99], v[72:75], v[56:59], v[96:99]
    v_mfma_f32_16x16x32_bf16 v[100:103], v[72:75], v[60:63], v[100:103]
    v_mfma_f32_16x16x32_bf16 v[104:107], v[72:75], v[64:67], v[104:107]
    v_mfma_f32_16x16x32_bf16 v[108:111], v[72:75], v[68:71], v[108:111]
    s_nop 3
    s_waitcnt vmcnt(5)
    s_mov_b32 s44, 1548288
    s_mov_b32 m0, 35328
    s_nop 0
    buffer_load_dwordx4 v4, s[40:43], s44 offen  lds
    s_waitcnt vmcnt(5)
    s_mov_b32 s44, 1576960
    s_mov_b32 m0, 36352
    s_nop 0
    buffer_load_dwordx4 v4, s[40:43], s44 offen  lds
    s_waitcnt vmcnt(5)
    s_mov_b32 s44, 1605632
    s_mov_b32 m0, 8704
    s_nop 0
    buffer_load_dwordx4 v4, s[40:43], s44 offen  lds
    s_waitcnt vmcnt(5)
    s_mov_b32 s44, 1634304
    s_mov_b32 m0, 9728
    s_nop 0
    buffer_load_dwordx4 v4, s[40:43], s44 offen  lds
    ds_read_b64_tr_b16 v[56:57], v6 offset:29184
    ds_read_b64_tr_b16 v[58:59], v6 offset:29696
    ds_read_b64_tr_b16 v[60:61], v6 offset:29216
    ds_read_b64_tr_b16 v[62:63], v6 offset:29728
    ds_read_b64_tr_b16 v[64:65], v6 offset:29248
    ds_read_b64_tr_b16 v[66:67], v6 offset:29760
    ds_read_b64_tr_b16 v[68:69], v6 offset:29280
    ds_read_b64_tr_b16 v[70:71], v6 offset:29792
    ds_read_b128 v[72:75], v7 offset:5376
    s_waitcnt lgkmcnt(0)
    v_mfma_f32_16x16x32_bf16 v[96:99], v[72:75], v[56:59], v[96:99]
    v_mfma_f32_16x16x32_bf16 v[100:103], v[72:75], v[60:63], v[100:103]
    v_mfma_f32_16x16x32_bf16 v[104:107], v[72:75], v[64:67], v[104:107]
    v_mfma_f32_16x16x32_bf16 v[108:111], v[72:75], v[68:71], v[108:111]
    s_nop 3
    s_waitcnt vmcnt(5)
    s_mov_b32 s44, 1662976
    s_mov_b32 m0, 10752
    s_nop 0
    buffer_load_dwordx4 v4, s[40:43], s44 offen  lds
    s_waitcnt vmcnt(5)
    s_mov_b32 s44, 1691648
    s_mov_b32 m0, 11776
    s_nop 0
    buffer_load_dwordx4 v4, s[40:43], s44 offen  lds
    s_waitcnt vmcnt(5)
    s_mov_b32 s44, 1720320
    s_mov_b32 m0, 12800
    s_nop 0
    buffer_load_dwordx4 v4, s[40:43], s44 offen  lds
    s_waitcnt vmcnt(5)
    s_mov_b32 s44, 1748992
    s_mov_b32 m0, 13824
    s_nop 0
    buffer_load_dwordx4 v4, s[40:43], s44 offen  lds
    ds_read_b64_tr_b16 v[56:57], v6 offset:33280
    ds_read_b64_tr_b16 v[58:59], v6 offset:33792
    ds_read_b64_tr_b16 v[60:61], v6 offset:33312
    ds_read_b64_tr_b16 v[62:63], v6 offset:33824
    ds_read_b64_tr_b16 v[64:65], v6 offset:33344
    ds_read_b64_tr_b16 v[66:67], v6 offset:33856
    ds_read_b64_tr_b16 v[68:69], v6 offset:33376
    ds_read_b64_tr_b16 v[70:71], v6 offset:33888
    ds_read_b128 v[72:75], v7 offset:5440
    s_waitcnt lgkmcnt(0)
    v_mfma_f32_16x16x32_bf16 v[96:99], v[72:75], v[56:59], v[96:99]
    v_mfma_f32_16x16x32_bf16 v[100:103], v[72:75], v[60:63], v[100:103]
    v_mfma_f32_16x16x32_bf16 v[104:107], v[72:75], v[64:67], v[104:107]
    v_mfma_f32_16x16x32_bf16 v[108:111], v[72:75], v[68:71], v[108:111]
    s_nop 3
    s_waitcnt vmcnt(5)
    s_mov_b32 s44, 1777664
    s_mov_b32 m0, 14848
    s_nop 0
    buffer_load_dwordx4 v4, s[40:43], s44 offen  lds
    s_waitcnt vmcnt(5)
    s_mov_b32 s44, 1806336
    s_mov_b32 m0, 15872
    s_nop 0
    buffer_load_dwordx4 v4, s[40:43], s44 offen  lds
    s_waitcnt vmcnt(4)
    ds_read_b64_tr_b16 v[56:57], v6 offset:8704
    ds_read_b64_tr_b16 v[58:59], v6 offset:9216
    ds_read_b64_tr_b16 v[60:61], v6 offset:8736
    ds_read_b64_tr_b16 v[62:63], v6 offset:9248
    ds_read_b64_tr_b16 v[64:65], v6 offset:8768
    ds_read_b64_tr_b16 v[66:67], v6 offset:9280
    ds_read_b64_tr_b16 v[68:69], v6 offset:8800
    ds_read_b64_tr_b16 v[70:71], v6 offset:9312
    ds_read_b128 v[72:75], v7 offset:5504
    s_waitcnt lgkmcnt(0)
    v_mfma_f32_16x16x32_bf16 v[96:99], v[72:75], v[56:59], v[96:99]
    v_mfma_f32_16x16x32_bf16 v[100:103], v[72:75], v[60:63], v[100:103]
    v_mfma_f32_16x16x32_bf16 v[104:107], v[72:75], v[64:67], v[104:107]
    v_mfma_f32_16x16x32_bf16 v[108:111], v[72:75], v[68:71], v[108:111]
    s_nop 3
    s_waitcnt vmcnt(0)
    ds_read_b64_tr_b16 v[56:57], v6 offset:12800
    ds_read_b64_tr_b16 v[58:59], v6 offset:13312
    ds_read_b64_tr_b16 v[60:61], v6 offset:12832
    ds_read_b64_tr_b16 v[62:63], v6 offset:13344
    ds_read_b64_tr_b16 v[64:65], v6 offset:12864
    ds_read_b64_tr_b16 v[66:67], v6 offset:13376
    ds_read_b64_tr_b16 v[68:69], v6 offset:12896
    ds_read_b64_tr_b16 v[70:71], v6 offset:13408
    ds_read_b128 v[72:75], v7 offset:5568
    s_waitcnt lgkmcnt(0)
    v_mfma_f32_16x16x32_bf16 v[96:99], v[72:75], v[56:59], v[96:99]
    v_mfma_f32_16x16x32_bf16 v[100:103], v[72:75], v[60:63], v[100:103]
    v_mfma_f32_16x16x32_bf16 v[104:107], v[72:75], v[64:67], v[104:107]
    v_mfma_f32_16x16x32_bf16 v[108:111], v[72:75], v[68:71], v[108:111]
    s_nop 3
    s_nop 1
    v_mov_b32_dpp v96, v100 quad_perm:[0,1,2,3] row_mask:0x2 bank_mask:0xf
    v_mov_b32_dpp v97, v101 quad_perm:[0,1,2,3] row_mask:0x2 bank_mask:0xf
    v_mov_b32_dpp v98, v102 quad_perm:[0,1,2,3] row_mask:0x2 bank_mask:0xf
    v_mov_b32_dpp v99, v103 quad_perm:[0,1,2,3] row_mask:0x2 bank_mask:0xf
    v_mov_b32_dpp v96, v104 quad_perm:[0,1,2,3] row_mask:0x4 bank_mask:0xf
    v_mov_b32_dpp v97, v105 quad_perm:[0,1,2,3] row_mask:0x4 bank_mask:0xf
    v_mov_b32_dpp v98, v106 quad_perm:[0,1,2,3] row_mask:0x4 bank_mask:0xf
    v_mov_b32_dpp v99, v107 quad_perm:[0,1,2,3] row_mask:0x4 bank_mask:0xf
    v_mov_b32_dpp v96, v108 quad_perm:[0,1,2,3] row_mask:0x8 bank_mask:0xf
    v_mov_b32_dpp v97, v109 quad_perm:[0,1,2,3] row_mask:0x8 bank_mask:0xf
    v_mov_b32_dpp v98, v110 quad_perm:[0,1,2,3] row_mask:0x8 bank_mask:0xf
    v_mov_b32_dpp v99, v111 quad_perm:[0,1,2,3] row_mask:0x8 bank_mask:0xf
    v_cvt_pk_bf16_f32 v96, 0, v96
    v_cvt_pk_bf16_f32 v97, 0, v97
    v_cvt_pk_bf16_f32 v98, 0, v98
    v_cvt_pk_bf16_f32 v99, 0, v99
    v_or_b32 v96, v96, v32
    v_or_b32 v97, v97, v33
    v_or_b32 v98, v98, v34
    v_or_b32 v99, v99, v35
    buffer_store_dwordx4 v[96:99], v5, s[52:55], s45 offen sc1
    s_add_u32 m0, s34, 0
    s_mov_b32 s63, 0
    buffer_load_dwordx4 v37, s[48:51], s63 offen  lds
    s_add_u32 m0, s34, 1024
    s_mov_b32 s63, 4096
    buffer_load_dwordx4 v37, s[48:51], s63 offen  lds
    s_add_u32 m0, s34, 2048
    s_mov_b32 s63, 8192
    buffer_load_dwordx4 v37, s[48:51], s63 offen  lds
    s_waitcnt vmcnt(2) lgkmcnt(0)
    s_add_u32 m0, s34, 3072
    s_mov_b32 s63, 12288
    buffer_load_dwordx4 v37, s[48:51], s63 offen  lds
    s_waitcnt vmcnt(2) lgkmcnt(0)
    s_add_u32 m0, s34, 4096
    s_mov_b32 s63, 16384
    buffer_load_dwordx4 v37, s[48:51], s63 offen  lds
    s_waitcnt vmcnt(2) lgkmcnt(0)
    s_add_u32 m0, s34, 5120
    s_mov_b32 s63, 20480
    buffer_load_dwordx4 v37, s[48:51], s63 offen  lds
    s_waitcnt vmcnt(2) lgkmcnt(0)
    s_add_u32 m0, s34, 6144
    s_mov_b32 s63, 24576
    buffer_load_dwordx4 v37, s[48:51], s63 offen  lds
    ds_read_b64_tr_b16 v[128:129], v3 offset:0
    ds_read_b64_tr_b16 v[136:137], v3 offset:32
    ds_read_b64_tr_b16 v[144:145], v3 offset:64
    ds_read_b64_tr_b16 v[152:153], v3 offset:96
    ds_read_b64_tr_b16 v[160:161], v3 offset:128
    ds_read_b64_tr_b16 v[168:169], v3 offset:160
    ds_read_b64_tr_b16 v[176:177], v3 offset:192
    ds_read_b64_tr_b16 v[184:185], v3 offset:224
    s_waitcnt vmcnt(2) lgkmcnt(0)
    s_add_u32 m0, s34, 7168
    s_mov_b32 s63, 28672
    buffer_load_dwordx4 v37, s[48:51], s63 offen  lds
    s_waitcnt vmcnt(2) lgkmcnt(0)
    s_add_u32 m0, s34, 0
    s_mov_b32 s63, 32768
    buffer_load_dwordx4 v37, s[48:51], s63 offen  lds
    s_waitcnt vmcnt(2) lgkmcnt(0)
    s_add_u32 m0, s34, 1024
    s_mov_b32 s63, 36864
    buffer_load_dwordx4 v37, s[48:51], s63 offen  lds
    s_waitcnt vmcnt(2) lgkmcnt(0)
    s_add_u32 m0, s34, 2048
    s_mov_b32 s63, 40960
    buffer_load_dwordx4 v37, s[48:51], s63 offen  lds
    ds_read_b64_tr_b16 v[130:131], v3 offset:4096
    ds_read_b64_tr_b16 v[138:139], v3 offset:4128
    ds_read_b64_tr_b16 v[146:147], v3 offset:4160
    ds_read_b64_tr_b16 v[154:155], v3 offset:4192
    ds_read_b64_tr_b16 v[162:163], v3 offset:4224
    ds_read_b64_tr_b16 v[170:171], v3 offset:4256
    ds_read_b64_tr_b16 v[178:179], v3 offset:4288
    ds_read_b64_tr_b16 v[186:187], v3 offset:4320
    s_waitcnt vmcnt(2) lgkmcnt(0)
    s_add_u32 m0, s34, 3072
    s_mov_b32 s63, 45056
    buffer_load_dwordx4 v37, s[48:51], s63 offen  lds
    s_waitcnt vmcnt(2) lgkmcnt(0)
    s_add_u32 m0, s34, 4096
    s_mov_b32 s63, 49152
    buffer_load_dwordx4 v37, s[48:51], s63 offen  lds
    s_waitcnt vmcnt(2) lgkmcnt(0)
    s_add_u32 m0, s34, 5120
    s_mov_b32 s63, 53248
    buffer_load_dwordx4 v37, s[48:51], s63 offen  lds
    s_waitcnt vmcnt(2) lgkmcnt(0)
    s_add_u32 m0, s34, 6144
    s_mov_b32 s63, 57344
    buffer_load_dwordx4 v37, s[48:51], s63 offen  lds
    ds_read_b64_tr_b16 v[132:133], v3 offset:0
    ds_read_b64_tr_b16 v[140:141], v3 offset:32
    ds_read_b64_tr_b16 v[148:149], v3 offset:64
    ds_read_b64_tr_b16 v[156:157], v3 offset:96
    ds_read_b64_tr_b16 v[164:165], v3 offset:128
    ds_read_b64_tr_b16 v[172:173], v3 offset:160
    ds_read_b64_tr_b16 v[180:181], v3 offset:192
    ds_read_b64_tr_b16 v[188:189], v3 offset:224
    s_waitcnt vmcnt(2) lgkmcnt(0)
    s_add_u32 m0, s34, 7168
    s_mov_b32 s63, 61440
    buffer_load_dwordx4 v37, s[48:51], s63 offen  lds
    s_waitcnt vmcnt(2) lgkmcnt(0)
    s_add_u32 m0, s34, 0
    s_mov_b32 s63, 65536
    buffer_load_dwordx4 v37, s[48:51], s63 offen  lds
    s_waitcnt vmcnt(2) lgkmcnt(0)
    s_add_u32 m0, s34, 1024
    s_mov_b32 s63, 69632
    buffer_load_dwordx4 v37, s[48:51], s63 offen  lds
    s_waitcnt vmcnt(2) lgkmcnt(0)
    s_add_u32 m0, s34, 2048
    s_mov_b32 s63, 73728
    buffer_load_dwordx4 v37, s[48:51], s63 offen  lds
    ds_read_b64_tr_b16 v[134:135], v3 offset:4096
    ds_read_b64_tr_b16 v[142:143], v3 offset:4128
    ds_read_b64_tr_b16 v[150:151], v3 offset:4160
    ds_read_b64_tr_b16 v[158:159], v3 offset:4192
    ds_read_b64_tr_b16 v[166:167], v3 offset:4224
    ds_read_b64_tr_b16 v[174:175], v3 offset:4256
    ds_read_b64_tr_b16 v[182:183], v3 offset:4288
    ds_read_b64_tr_b16 v[190:191], v3 offset:4320
    s_waitcnt vmcnt(2) lgkmcnt(0)
    s_add_u32 m0, s34, 3072
    s_mov_b32 s63, 77824
    buffer_load_dwordx4 v37, s[48:51], s63 offen  lds
    s_waitcnt vmcnt(2) lgkmcnt(0)
    s_add_u32 m0, s34, 4096
    s_mov_b32 s63, 81920
    buffer_load_dwordx4 v37, s[48:51], s63 offen  lds
    s_waitcnt vmcnt(2) lgkmcnt(0)
    s_add_u32 m0, s34, 5120
    s_mov_b32 s63, 86016
    buffer_load_dwordx4 v37, s[48:51], s63 offen  lds
    s_waitcnt vmcnt(2) lgkmcnt(0)
    s_add_u32 m0, s34, 6144
    s_mov_b32 s63, 90112
    buffer_load_dwordx4 v37, s[48:51], s63 offen  lds
    ds_read_b64_tr_b16 v[192:193], v3 offset:0
    ds_read_b64_tr_b16 v[200:201], v3 offset:32
    ds_read_b64_tr_b16 v[208:209], v3 offset:64
    ds_read_b64_tr_b16 v[216:217], v3 offset:96
    ds_read_b64_tr_b16 v[224:225], v3 offset:128
    ds_read_b64_tr_b16 v[232:233], v3 offset:160
    ds_read_b64_tr_b16 v[240:241], v3 offset:192
    ds_read_b64_tr_b16 v[248:249], v3 offset:224
    s_waitcnt vmcnt(2) lgkmcnt(0)
    s_add_u32 m0, s34, 7168
    s_mov_b32 s63, 94208
    buffer_load_dwordx4 v37, s[48:51], s63 offen  lds
    s_waitcnt vmcnt(2) lgkmcnt(0)
    s_add_u32 m0, s34, 0
    s_mov_b32 s63, 98304
    buffer_load_dwordx4 v37, s[48:51], s63 offen  lds
    s_waitcnt vmcnt(2) lgkmcnt(0)
    s_add_u32 m0, s34, 1024
    s_mov_b32 s63, 102400
    buffer_load_dwordx4 v37, s[48:51], s63 offen  lds
    s_waitcnt vmcnt(2) lgkmcnt(0)
    s_add_u32 m0, s34, 2048
    s_mov_b32 s63, 106496
    buffer_load_dwordx4 v37, s[48:51], s63 offen  lds
    ds_read_b64_tr_b16 v[194:195], v3 offset:4096
    ds_read_b64_tr_b16 v[202:203], v3 offset:4128
    ds_read_b64_tr_b16 v[210:211], v3 offset:4160
    ds_read_b64_tr_b16 v[218:219], v3 offset:4192
    ds_read_b64_tr_b16 v[226:227], v3 offset:4224
    ds_read_b64_tr_b16 v[234:235], v3 offset:4256
    ds_read_b64_tr_b16 v[242:243], v3 offset:4288
    ds_read_b64_tr_b16 v[250:251], v3 offset:4320
    s_waitcnt vmcnt(2) lgkmcnt(0)
    s_add_u32 m0, s34, 3072
    s_mov_b32 s63, 110592
    buffer_load_dwordx4 v37, s[48:51], s63 offen  lds
    s_waitcnt vmcnt(2) lgkmcnt(0)
    s_add_u32 m0, s34, 4096
    s_mov_b32 s63, 114688
    buffer_load_dwordx4 v37, s[48:51], s63 offen  lds
    s_waitcnt vmcnt(2) lgkmcnt(0)
    s_add_u32 m0, s34, 5120
    s_mov_b32 s63, 118784
    buffer_load_dwordx4 v37, s[48:51], s63 offen  lds
    s_waitcnt vmcnt(2) lgkmcnt(0)
    s_add_u32 m0, s34, 6144
    s_mov_b32 s63, 122880
    buffer_load_dwordx4 v37, s[48:51], s63 offen  lds
    ds_read_b64_tr_b16 v[196:197], v3 offset:0
    ds_read_b64_tr_b16 v[204:205], v3 offset:32
    ds_read_b64_tr_b16 v[212:213], v3 offset:64
    ds_read_b64_tr_b16 v[220:221], v3 offset:96
    ds_read_b64_tr_b16 v[228:229], v3 offset:128
    ds_read_b64_tr_b16 v[236:237], v3 offset:160
    ds_read_b64_tr_b16 v[244:245], v3 offset:192
    ds_read_b64_tr_b16 v[252:253], v3 offset:224
    s_waitcnt vmcnt(2) lgkmcnt(0)
    s_add_u32 m0, s34, 7168
    s_mov_b32 s63, 126976
    buffer_load_dwordx4 v37, s[48:51], s63 offen  lds
    s_waitcnt vmcnt(0)
    ds_read_b64_tr_b16 v[198:199], v3 offset:4096
    ds_read_b64_tr_b16 v[206:207], v3 offset:4128
    ds_read_b64_tr_b16 v[214:215], v3 offset:4160
    ds_read_b64_tr_b16 v[222:223], v3 offset:4192
    ds_read_b64_tr_b16 v[230:231], v3 offset:4224
    ds_read_b64_tr_b16 v[238:239], v3 offset:4256
    ds_read_b64_tr_b16 v[246:247], v3 offset:4288
    ds_read_b64_tr_b16 v[254:255], v3 offset:4320
    s_waitcnt lgkmcnt(0)
    s_branch L_tail
L_notF1:
    s_lshr_b32 s45, s29, 3
    s_cmp_eq_u32 s45, 1
    s_cbranch_scc1 L_F2
    s_cmp_eq_u32 s29, 20
    s_cbranch_scc1 L_rl
    s_add_u32 m0, s34, 0
    s_mov_b32 s63, 0
    buffer_load_dwordx4 v37, s[48:51], s63 offen  lds
    s_add_u32 m0, s34, 1024
    s_mov_b32 s63, 4096
    buffer_load_dwordx4 v37, s[48:51], s63 offen  lds
    s_waitcnt vmcnt(1) lgkmcnt(0)
    s_add_u32 m0, s34, 2048
    s_mov_b32 s63, 8192
    buffer_load_dwordx4 v37, s[48:51], s63 offen  lds
    s_waitcnt vmcnt(1) lgkmcnt(0)
    s_add_u32 m0, s34, 3072
    s_mov_b32 s63, 12288
    buffer_load_dwordx4 v37, s[48:51], s63 offen  lds
    s_waitcnt vmcnt(1) lgkmcnt(0)
    s_add_u32 m0, s34, 4096
    s_mov_b32 s63, 16384
    buffer_load_dwordx4 v37, s[48:51], s63 offen  lds
    s_waitcnt vmcnt(1) lgkmcnt(0)
    s_add_u32 m0, s34, 5120
    s_mov_b32 s63, 20480
    buffer_load_dwordx4 v37, s[48:51], s63 offen  lds
    ds_read_b64_tr_b16 v[128:129], v3 offset:0
    ds_read_b64_tr_b16 v[136:137], v3 offset:32
    ds_read_b64_tr_b16 v[144:145], v3 offset:64
    ds_read_b64_tr_b16 v[152:153], v3 offset:96
    ds_read_b64_tr_b16 v[160:161], v3 offset:128
    ds_read_b64_tr_b16 v[168:169], v3 offset:160
    ds_read_b64_tr_b16 v[176:177], v3 offset:192
    ds_read_b64_tr_b16 v[184:185], v3 offset:224
    s_waitcnt vmcnt(1) lgkmcnt(0)
    s_add_u32 m0, s34, 6144
    s_mov_b32 s63, 24576
    buffer_load_dwordx4 v37, s[48:51], s63 offen  lds
    s_waitcnt vmcnt(1) lgkmcnt(0)
    s_add_u32 m0, s34, 7168
    s_mov_b32 s63, 28672
    buffer_load_dwordx4 v37, s[48:51], s63 offen  lds
    s_waitcnt vmcnt(1) lgkmcnt(0)
    s_add_u32 m0, s34, 0
    s_mov_b32 s63, 32768
    buffer_load_dwordx4 v37, s[48:51], s63 offen  lds
    s_waitcnt vmcnt(1) lgkmcnt(0)
    s_add_u32 m0, s34, 1024
    s_mov_b32 s63, 36864
    buffer_load_dwordx4 v37, s[48:51], s63 offen  lds
    ds_read_b64_tr_b16 v[130:131], v3 offset:4096
    ds_read_b64_tr_b16 v[138:139], v3 offset:4128
    ds_read_b64_tr_b16 v[146:147], v3 offset:4160
    ds_read_b64_tr_b16 v[154:155], v3 offset:4192
    ds_read_b64_tr_b16 v[162:163], v3 offset:4224
    ds_read_b64_tr_b16 v[170:171], v3 offset:4256
    ds_read_b64_tr_b16 v[178:179], v3 offset:4288
    ds_read_b64_tr_b16 v[186:187], v3 offset:4320
    s_waitcnt vmcnt(1) lgkmcnt(0)
    s_add_u32 m0, s34, 2048
    s_mov_b32 s63, 40960
    buffer_load_dwordx4 v37, s[48:51], s63 offen  lds
    s_waitcnt vmcnt(1) lgkmcnt(0)
    s_add_u32 m0, s34, 3072
    s_mov_b32 s63, 45056
    buffer_load_dwordx4 v37, s[48:51], s63 offen  lds
    s_waitcnt vmcnt(1) lgkmcnt(0)
    s_add_u32 m0, s34, 4096
    s_mov_b32 s63, 49152
    buffer_load_dwordx4 v37, s[48:51], s63 offen  lds
    s_waitcnt vmcnt(1) lgkmcnt(0)
    s_add_u32 m0, s34, 5120
    s_mov_b32 s63, 53248
    buffer_load_dwordx4 v37, s[48:51], s63 offen  lds
    ds_read_b64_tr_b16 v[132:133], v3 offset:0
    ds_read_b64_tr_b16 v[140:141], v3 offset:32
    ds_read_b64_tr_b16 v[148:149], v3 offset:64
    ds_read_b64_tr_b16 v[156:157], v3 offset:96
    ds_read_b64_tr_b16 v[164:165], v3 offset:128
    ds_read_b64_tr_b16 v[172:173], v3 offset:160
    ds_read_b64_tr_b16 v[180:181], v3 offset:192
    ds_read_b64_tr_b16 v[188:189], v3 offset:224
    s_waitcnt vmcnt(1) lgkmcnt(0)
    s_add_u32 m0, s34, 6144
    s_mov_b32 s63, 57344
    buffer_load_dwordx4 v37, s[48:51], s63 offen  lds
    s_waitcnt vmcnt(1) lgkmcnt(0)
    s_add_u32 m0, s34, 7168
    s_mov_b32 s63, 61440
    buffer_load_dwordx4 v37, s[48:51], s63 offen  lds
    s_waitcnt vmcnt(1) lgkmcnt(0)
    s_add_u32 m0, s34, 0
    s_mov_b32 s63, 65536
    buffer_load_dwordx4 v37, s[48:51], s63 offen  lds
    s_waitcnt vmcnt(1) lgkmcnt(0)
    s_add_u32 m0, s34, 1024
    s_mov_b32 s63, 69632
    buffer_load_dwordx4 v37, s[48:51], s63 offen  lds
    ds_read_b64_tr_b16 v[134:135], v3 offset:4096
    ds_read_b64_tr_b16 v[142:143], v3 offset:4128
    ds_read_b64_tr_b16 v[150:151], v3 offset:4160
    ds_read_b64_tr_b16 v[158:159], v3 offset:4192
    ds_read_b64_tr_b16 v[166:167], v3 offset:4224
    ds_read_b64_tr_b16 v[174:175], v3 offset:4256
    ds_read_b64_tr_b16 v[182:183], v3 offset:4288
    ds_read_b64_tr_b16 v[190:191], v3 offset:4320
    s_waitcnt vmcnt(1) lgkmcnt(0)
    s_add_u32 m0, s34, 2048
    s_mov_b32 s63, 73728
    buffer_load_dwordx4 v37, s[48:51], s63 offen  lds
    s_waitcnt vmcnt(1) lgkmcnt(0)
    s_add_u32 m0, s34, 3072
    s_mov_b32 s63, 77824
    buffer_load_dwordx4 v37, s[48:51], s63 offen  lds
    s_waitcnt vmcnt(1) lgkmcnt(0)
    s_add_u32 m0, s34, 4096
    s_mov_b32 s63, 81920
    buffer_load_dwordx4 v37, s[48:51], s63 offen  lds
    s_waitcnt vmcnt(1) lgkmcnt(0)
    s_add_u32 m0, s34, 5120
    s_mov_b32 s63, 86016
    buffer_load_dwordx4 v37, s[48:51], s63 offen  lds
    ds_read_b64_tr_b16 v[192:193], v3 offset:0
    ds_read_b64_tr_b16 v[200:201], v3 offset:32
    ds_read_b64_tr_b16 v[208:209], v3 offset:64
    ds_read_b64_tr_b16 v[216:217], v3 offset:96
    ds_read_b64_tr_b16 v[224:225], v3 offset:128
    ds_read_b64_tr_b16 v[232:233], v3 offset:160
    ds_read_b64_tr_b16 v[240:241], v3 offset:192
    ds_read_b64_tr_b16 v[248:249], v3 offset:224
    s_waitcnt vmcnt(1) lgkmcnt(0)
    s_add_u32 m0, s34, 6144
    s_mov_b32 s63, 90112
    buffer_load_dwordx4 v37, s[48:51], s63 offen  lds
    s_waitcnt vmcnt(1) lgkmcnt(0)
    s_add_u32 m0, s34, 7168
    s_mov_b32 s63, 94208
    buffer_load_dwordx4 v37, s[48:51], s63 offen  lds
    s_waitcnt vmcnt(1) lgkmcnt(0)
    s_add_u32 m0, s34, 0
    s_mov_b32 s63, 98304
    buffer_load_dwordx4 v37, s[48:51], s63 offen  lds
    s_waitcnt vmcnt(1) lgkmcnt(0)
    s_add_u32 m0, s34, 1024
    s_mov_b32 s63, 102400
    buffer_load_dwordx4 v37, s[48:51], s63 offen  lds
    ds_read_b64_tr_b16 v[194:195], v3 offset:4096
    ds_read_b64_tr_b16 v[202:203], v3 offset:4128
    ds_read_b64_tr_b16 v[210:211], v3 offset:4160
    ds_read_b64_tr_b16 v[218:219], v3 offset:4192
    ds_read_b64_tr_b16 v[226:227], v3 offset:4224
    ds_read_b64_tr_b16 v[234:235], v3 offset:4256
    ds_read_b64_tr_b16 v[242:243], v3 offset:4288
    ds_read_b64_tr_b16 v[250:251], v3 offset:4320
    s_waitcnt vmcnt(1) lgkmcnt(0)
    s_add_u32 m0, s34, 2048
    s_mov_b32 s63, 106496
    buffer_load_dwordx4 v37, s[48:51], s63 offen  lds
    s_waitcnt vmcnt(1) lgkmcnt(0)
    s_add_u32 m0, s34, 3072
    s_mov_b32 s63, 110592
    buffer_load_dwordx4 v37, s[48:51], s63 offen  lds
    s_waitcnt vmcnt(1) lgkmcnt(0)
    s_add_u32 m0, s34, 4096
    s_mov_b32 s63, 114688
    buffer_load_dwordx4 v37, s[48:51], s63 offen  lds
    s_waitcnt vmcnt(1) lgkmcnt(0)
    s_add_u32 m0, s34, 5120
    s_mov_b32 s63, 118784
    buffer_load_dwordx4 v37, s[48:51], s63 offen  lds
    ds_read_b64_tr_b16 v[196:197], v3 offset:0
    ds_read_b64_tr_b16 v[204:205], v3 offset:32
    ds_read_b64_tr_b16 v[212:213], v3 offset:64
    ds_read_b64_tr_b16 v[220:221], v3 offset:96
    ds_read_b64_tr_b16 v[228:229], v3 offset:128
    ds_read_b64_tr_b16 v[236:237], v3 offset:160
    ds_read_b64_tr_b16 v[244:245], v3 offset:192
    ds_read_b64_tr_b16 v[252:253], v3 offset:224
    s_waitcnt vmcnt(1) lgkmcnt(0)
    s_add_u32 m0, s34, 6144
    s_mov_b32 s63, 122880
    buffer_load_dwordx4 v37, s[48:51], s63 offen  lds
    s_waitcnt vmcnt(1) lgkmcnt(0)
    s_add_u32 m0, s34, 7168
    s_mov_b32 s63, 126976
    buffer_load_dwordx4 v37, s[48:51], s63 offen  lds
    s_waitcnt vmcnt(0)
    ds_read_b64_tr_b16 v[198:199], v3 offset:4096
    ds_read_b64_tr_b16 v[206:207], v3 offset:4128
    ds_read_b64_tr_b16 v[214:215], v3 offset:4160
    ds_read_b64_tr_b16 v[222:223], v3 offset:4192
    ds_read_b64_tr_b16 v[230:231], v3 offset:4224
    ds_read_b64_tr_b16 v[238:239], v3 offset:4256
    ds_read_b64_tr_b16 v[246:247], v3 offset:4288
    ds_read_b64_tr_b16 v[254:255], v3 offset:4320
    s_waitcnt lgkmcnt(0)
    s_branch L_tail
L_rl:
    s_lshl_b32 s45, s28, 12
    s_add_u32 s45, s45, 1183744
    v_mov_b32 v28, s74
    v_and_b32 v29, 31, v0
    v_lshlrev_b32 v29, 2, v29
    s_movk_i32 s44, 128
    s_add_u32 m0, s34, 0
    s_mov_b32 s63, 0
    buffer_load_dwordx4 v37, s[48:51], s63 offen  lds
    s_add_u32 m0, s34, 1024
    s_mov_b32 s63, 4096
    buffer_load_dwordx4 v37, s[48:51], s63 offen  lds
    s_add_u32 m0, s34, 2048
    s_mov_b32 s63, 8192
    buffer_load_dwordx4 v37, s[48:51], s63 offen  lds
    s_waitcnt vmcnt(2) lgkmcnt(0)
    s_add_u32 m0, s34, 3072
    s_mov_b32 s63, 12288
    buffer_load_dwordx4 v37, s[48:51], s63 offen  lds
    s_waitcnt vmcnt(2) lgkmcnt(0)
    s_add_u32 m0, s34, 4096
    s_mov_b32 s63, 16384
    buffer_load_dwordx4 v37, s[48:51], s63 offen  lds
    s_waitcnt vmcnt(2) lgkmcnt(0)
    s_add_u32 m0, s34, 5120
    s_mov_b32 s63, 20480
    buffer_load_dwordx4 v37, s[48:51], s63 offen  lds
    s_waitcnt vmcnt(2) lgkmcnt(0)
    s_add_u32 m0, s34, 6144
    s_mov_b32 s63, 24576
    buffer_load_dwordx4 v37, s[48:51], s63 offen  lds
    ds_read_b64_tr_b16 v[128:129], v3 offset:0
    ds_read_b64_tr_b16 v[136:137], v3 offset:32
    ds_read_b64_tr_b16 v[144:145], v3 offset:64
    ds_read_b64_tr_b16 v[152:153], v3 offset:96
    ds_read_b64_tr_b16 v[160:161], v3 offset:128
    ds_read_b64_tr_b16 v[168:169], v3 offset:160
    ds_read_b64_tr_b16 v[176:177], v3 offset:192
    ds_read_b64_tr_b16 v[184:185], v3 offset:224
    s_waitcnt vmcnt(2) lgkmcnt(0)
    s_add_u32 m0, s34, 7168
    s_mov_b32 s63, 28672
    buffer_load_dwordx4 v37, s[48:51], s63 offen  lds
    s_waitcnt vmcnt(2) lgkmcnt(0)
    s_add_u32 m0, s34, 0
    s_mov_b32 s63, 32768
    buffer_load_dwordx4 v37, s[48:51], s63 offen  lds
    s_waitcnt vmcnt(2) lgkmcnt(0)
    s_add_u32 m0, s34, 1024
    s_mov_b32 s63, 36864
    buffer_load_dwordx4 v37, s[48:51], s63 offen  lds
    s_waitcnt vmcnt(2) lgkmcnt(0)
    s_add_u32 m0, s34, 2048
    s_mov_b32 s63, 40960
    buffer_load_dwordx4 v37, s[48:51], s63 offen  lds
    ds_read_b64_tr_b16 v[130:131], v3 offset:4096
    ds_read_b64_tr_b16 v[138:139], v3 offset:4128
    ds_read_b64_tr_b16 v[146:147], v3 offset:4160
    ds_read_b64_tr_b16 v[154:155], v3 offset:4192
    ds_read_b64_tr_b16 v[162:163], v3 offset:4224
    ds_read_b64_tr_b16 v[170:171], v3 offset:4256
    ds_read_b64_tr_b16 v[178:179], v3 offset:4288
    ds_read_b64_tr_b16 v[186:187], v3 offset:4320
    s_waitcnt vmcnt(2) lgkmcnt(0)
    s_add_u32 m0, s34, 3072
    s_mov_b32 s63, 45056
    buffer_load_dwordx4 v37, s[48:51], s63 offen  lds
    s_waitcnt vmcnt(2) lgkmcnt(0)
    s_add_u32 m0, s34, 4096
    s_mov_b32 s63, 49152
    buffer_load_dwordx4 v37, s[48:51], s63 offen  lds
    s_waitcnt vmcnt(2) lgkmcnt(0)
    s_add_u32 m0, s34, 5120
    s_mov_b32 s63, 53248
    buffer_load_dwordx4 v37, s[48:51], s63 offen  lds
    s_waitcnt vmcnt(2) lgkmcnt(0)
    s_add_u32 m0, s34, 6144
    s_mov_b32 s63, 57344
    buffer_load_dwordx4 v37, s[48:51], s63 offen  lds
    ds_read_b64_tr_b16 v[132:133], v3 offset:0
    ds_read_b64_tr_b16 v[140:141], v3 offset:32
    ds_read_b64_tr_b16 v[148:149], v3 offset:64
    ds_read_b64_tr_b16 v[156:157], v3 offset:96
    ds_read_b64_tr_b16 v[164:165], v3 offset:128
    ds_read_b64_tr_b16 v[172:173], v3 offset:160
    ds_read_b64_tr_b16 v[180:181], v3 offset:192
    ds_read_b64_tr_b16 v[188:189], v3 offset:224
    s_waitcnt vmcnt(2) lgkmcnt(0)
    s_add_u32 m0, s34, 7168
    s_mov_b32 s63, 61440
    buffer_load_dwordx4 v37, s[48:51], s63 offen  lds
    s_waitcnt vmcnt(2) lgkmcnt(0)
    s_add_u32 m0, s34, 0
    s_mov_b32 s63, 65536
    buffer_load_dwordx4 v37, s[48:51], s63 offen  lds
    s_waitcnt vmcnt(2) lgkmcnt(0)
    s_add_u32 m0, s34, 1024
    s_mov_b32 s63, 69632
    buffer_load_dwordx4 v37, s[48:51], s63 offen  lds
    s_waitcnt vmcnt(2) lgkmcnt(0)
    s_add_u32 m0, s34, 2048
    s_mov_b32 s63, 73728
    buffer_load_dwordx4 v37, s[48:51], s63 offen  lds
    ds_read_b64_tr_b16 v[134:135], v3 offset:4096
    ds_read_b64_tr_b16 v[142:143], v3 offset:4128
    ds_read_b64_tr_b16 v[150:151], v3 offset:4160
    ds_read_b64_tr_b16 v[158:159], v3 offset:4192
    ds_read_b64_tr_b16 v[166:167], v3 offset:4224
    ds_read_b64_tr_b16 v[174:175], v3 offset:4256
    ds_read_b64_tr_b16 v[182:183], v3 offset:4288
    ds_read_b64_tr_b16 v[190:191], v3 offset:4320
    s_waitcnt vmcnt(2) lgkmcnt(0)
    s_add_u32 m0, s34, 3072
    s_mov_b32 s63, 77824
    buffer_load_dwordx4 v37, s[48:51], s63 offen  lds
    s_waitcnt vmcnt(2) lgkmcnt(0)
    s_add_u32 m0, s34, 4096
    s_mov_b32 s63, 81920
    buffer_load_dwordx4 v37, s[48:51], s63 offen  lds
    s_waitcnt vmcnt(2) lgkmcnt(0)
    s_add_u32 m0, s34, 5120
    s_mov_b32 s63, 86016
    buffer_load_dwordx4 v37, s[48:51], s63 offen  lds
    s_waitcnt vmcnt(2) lgkmcnt(0)
    s_add_u32 m0, s34, 6144
    s_mov_b32 s63, 90112
    buffer_load_dwordx4 v37, s[48:51], s63 offen  lds
    ds_read_b64_tr_b16 v[192:193], v3 offset:0
    ds_read_b64_tr_b16 v[200:201], v3 offset:32
    ds_read_b64_tr_b16 v[208:209], v3 offset:64
    ds_read_b64_tr_b16 v[216:217], v3 offset:96
    ds_read_b64_tr_b16 v[224:225], v3 offset:128
    ds_read_b64_tr_b16 v[232:233], v3 offset:160
    ds_read_b64_tr_b16 v[240:241], v3 offset:192
    ds_read_b64_tr_b16 v[248:249], v3 offset:224
    s_waitcnt vmcnt(2) lgkmcnt(0)
    s_add_u32 m0, s34, 7168
    s_mov_b32 s63, 94208
    buffer_load_dwordx4 v37, s[48:51], s63 offen  lds
    s_waitcnt vmcnt(2) lgkmcnt(0)
    s_add_u32 m0, s34, 0
    s_mov_b32 s63, 98304
    buffer_load_dwordx4 v37, s[48:51], s63 offen  lds
    s_waitcnt vmcnt(2) lgkmcnt(0)
    s_add_u32 m0, s34, 1024
    s_mov_b32 s63, 102400
    buffer_load_dwordx4 v37, s[48:51], s63 offen  lds
    s_waitcnt vmcnt(2) lgkmcnt(0)
    s_add_u32 m0, s34, 2048
    s_mov_b32 s63, 106496
    buffer_load_dwordx4 v37, s[48:51], s63 offen  lds
    ds_read_b64_tr_b16 v[194:195], v3 offset:4096
    ds_read_b64_tr_b16 v[202:203], v3 offset:4128
    ds_read_b64_tr_b16 v[210:211], v3 offset:4160
    ds_read_b64_tr_b16 v[218:219], v3 offset:4192
    ds_read_b64_tr_b16 v[226:227], v3 offset:4224
    ds_read_b64_tr_b16 v[234:235], v3 offset:4256
    ds_read_b64_tr_b16 v[242:243], v3 offset:4288
    ds_read_b64_tr_b16 v[250:251], v3 offset:4320
    s_waitcnt vmcnt(2) lgkmcnt(0)
    s_add_u32 m0, s34, 3072
    s_mov_b32 s63, 110592
    buffer_load_dwordx4 v37, s[48:51], s63 offen  lds
    s_waitcnt vmcnt(2) lgkmcnt(0)
    s_add_u32 m0, s34, 4096
    s_mov_b32 s63, 114688
    buffer_load_dwordx4 v37, s[48:51], s63 offen  lds
    s_waitcnt vmcnt(2) lgkmcnt(0)
    s_add_u32 m0, s34, 5120
    s_mov_b32 s63, 118784
    buffer_load_dwordx4 v37, s[48:51], s63 offen  lds
    s_waitcnt vmcnt(2) lgkmcnt(0)
    s_add_u32 m0, s34, 6144
    s_mov_b32 s63, 122880
    buffer_load_dwordx4 v37, s[48:51], s63 offen  lds
    ds_read_b64_tr_b16 v[196:197], v3 offset:0
    ds_read_b64_tr_b16 v[204:205], v3 offset:32
    ds_read_b64_tr_b16 v[212:213], v3 offset:64
    ds_read_b64_tr_b16 v[220:221], v3 offset:96
    ds_read_b64_tr_b16 v[228:229], v3 offset:128
    ds_read_b64_tr_b16 v[236:237], v3 offset:160
    ds_read_b64_tr_b16 v[244:245], v3 offset:192
    ds_read_b64_tr_b16 v[252:253], v3 offset:224
    s_waitcnt vmcnt(2) lgkmcnt(0)
    s_add_u32 m0, s34, 7168
    s_mov_b32 s63, 126976
    buffer_load_dwordx4 v37, s[48:51], s63 offen  lds
    s_waitcnt vmcnt(0)
    ds_read_b64_tr_b16 v[198:199], v3 offset:4096
    ds_read_b64_tr_b16 v[206:207], v3 offset:4128
    ds_read_b64_tr_b16 v[214:215], v3 offset:4160
    ds_read_b64_tr_b16 v[222:223], v3 offset:4192
    ds_read_b64_tr_b16 v[230:231], v3 offset:4224
    ds_read_b64_tr_b16 v[238:239], v3 offset:4256
    ds_read_b64_tr_b16 v[246:247], v3 offset:4288
    ds_read_b64_tr_b16 v[254:255], v3 offset:4320
    s_waitcnt lgkmcnt(0)
L_rg0:
    s_load_dwordx8 s[64:71], s[24:25], 0 glc
    s_waitcnt lgkmcnt(0)
    s_add_u32 s64, s64, s65
    s_add_u32 s64, s64, s66
    s_add_u32 s64, s64, s67
    s_add_u32 s64, s64, s68
    s_add_u32 s64, s64, s69
    s_add_u32 s64, s64, s70
    s_add_u32 s64, s64, s71
    s_cmp_ge_u32 s64, 4
    s_cbranch_scc1 L_rg0_ok
    s_sub_u32 s44, s44, 1
    s_cmp_gt_i32 s44, 0
    s_cbranch_scc1 L_rg0
L_rg0_ok:
    buffer_store_dword v28, v29, s[52:55], s45 offen offset:0
L_rg1:
    s_load_dwordx8 s[64:71], s[24:25], 32 glc
    s_waitcnt lgkmcnt(0)
    s_add_u32 s64, s64, s65
    s_add_u32 s64, s64, s66
    s_add_u32 s64, s64, s67
    s_add_u32 s64, s64, s68
    s_add_u32 s64, s64, s69
    s_add_u32 s64, s64, s70
    s_add_u32 s64, s64, s71
    s_cmp_ge_u32 s64, 4
    s_cbranch_scc1 L_rg1_ok
    s_sub_u32 s44, s44, 1
    s_cmp_gt_i32 s44, 0
    s_cbranch_scc1 L_rg1
L_rg1_ok:
    buffer_store_dword v28, v29, s[52:55], s45 offen offset:128
    s_branch L_tail
L_F2:
    s_and_b32 s46, s29, 7
    s_mul_i32 s60, s28, 229376
    s_lshl_b32 s45, s46, 7
    s_add_u32 s60, s60, s45
    s_sub_u32 s61, 1835008, s60
    s_add_u32 s40, s20, s60
    s_addc_u32 s41, s21, 0
    s_and_b32 s41, s41, 0xffff
    s_mov_b32 s42, s61
    s_mov_b32 s43, 0x20000
    s_lshl_b32 s46, s46, 3
    s_add_u32 s46, s46, s28
    s_lshl_b32 s46, s46, 10
    s_add_u32 s46, s46, 1114112
    v_lshlrev_b32 v4, 10, v38
    v_lshl_add_u32 v4, v39, 4, v4
    s_mov_b32 s44, 0
    s_mov_b32 m0, 8704
    s_nop 0
    buffer_load_dwordx4 v4, s[40:43], s44 offen  lds
    s_mov_b32 s44, 8192
    s_mov_b32 m0, 9728
    s_nop 0
    buffer_load_dwordx4 v4, s[40:43], s44 offen  lds
    s_mov_b32 s44, 16384
    s_mov_b32 m0, 10752
    s_nop 0
    buffer_load_dwordx4 v4, s[40:43], s44 offen  lds
    s_waitcnt vmcnt(2)
    s_mov_b32 s44, 24576
    s_mov_b32 m0, 11776
    s_nop 0
    buffer_load_dwordx4 v4, s[40:43], s44 offen  lds
    s_waitcnt vmcnt(2)
    s_mov_b32 s44, 32768
    s_mov_b32 m0, 12800
    s_nop 0
    buffer_load_dwordx4 v4, s[40:43], s44 offen  lds
    s_waitcnt vmcnt(2)
    s_mov_b32 s44, 40960
    s_mov_b32 m0, 13824
    s_nop 0
    buffer_load_dwordx4 v4, s[40:43], s44 offen  lds
    s_waitcnt vmcnt(2)
    s_mov_b32 s44, 49152
    s_mov_b32 m0, 14848
    s_nop 0
    buffer_load_dwordx4 v4, s[40:43], s44 offen  lds
    s_waitcnt vmcnt(2)
    s_mov_b32 s44, 57344
    s_mov_b32 m0, 15872
    s_nop 0
    buffer_load_dwordx4 v4, s[40:43], s44 offen  lds
    s_waitcnt vmcnt(2)
    s_mov_b32 s44, 65536
    s_mov_b32 m0, 16896
    s_nop 0
    buffer_load_dwordx4 v4, s[40:43], s44 offen  lds
    s_waitcnt vmcnt(2)
    s_mov_b32 s44, 73728
    s_mov_b32 m0, 17920
    s_nop 0
    buffer_load_dwordx4 v4, s[40:43], s44 offen  lds
    s_waitcnt vmcnt(2)
    s_mov_b32 s44, 81920
    s_mov_b32 m0, 18944
    s_nop 0
    buffer_load_dwordx4 v4, s[40:43], s44 offen  lds
    s_waitcnt vmcnt(2)
    s_mov_b32 s44, 90112
    s_mov_b32 m0, 19968
    s_nop 0
    buffer_load_dwordx4 v4, s[40:43], s44 offen  lds
    s_waitcnt vmcnt(2)
    s_mov_b32 s44, 98304
    s_mov_b32 m0, 20992
    s_nop 0
    buffer_load_dwordx4 v4, s[40:43], s44 offen  lds
    s_waitcnt vmcnt(2)
    s_mov_b32 s44, 106496
    s_mov_b32 m0, 22016
    s_nop 0
    buffer_load_dwordx4 v4, s[40:43], s44 offen  lds
    s_waitcnt vmcnt(2)
    s_mov_b32 s44, 114688
    s_mov_b32 m0, 23040
    s_nop 0
    buffer_load_dwordx4 v4, s[40:43], s44 offen  lds
    s_waitcnt vmcnt(2)
    s_mov_b32 s44, 122880
    s_mov_b32 m0, 24064
    s_nop 0
    buffer_load_dwordx4 v4, s[40:43], s44 offen  lds
    s_waitcnt vmcnt(2)
    s_mov_b32 s44, 131072
    s_mov_b32 m0, 25088
    s_nop 0
    buffer_load_dwordx4 v4, s[40:43], s44 offen  lds
    s_waitcnt vmcnt(2)
    s_mov_b32 s44, 139264
    s_mov_b32 m0, 26112
    s_nop 0
    buffer_load_dwordx4 v4, s[40:43], s44 offen  lds
    s_waitcnt vmcnt(2)
    s_mov_b32 s44, 147456
    s_mov_b32 m0, 27136
    s_nop 0
    buffer_load_dwordx4 v4, s[40:43], s44 offen  lds
    s_waitcnt vmcnt(2)
    s_mov_b32 s44, 155648
    s_mov_b32 m0, 28160
    s_nop 0
    buffer_load_dwordx4 v4, s[40:43], s44 offen  lds
    s_waitcnt vmcnt(2)
    s_mov_b32 s44, 163840
    s_mov_b32 m0, 29184
    s_nop 0
    buffer_load_dwordx4 v4, s[40:43], s44 offen  lds
    s_waitcnt vmcnt(2)
    s_mov_b32 s44, 172032
    s_mov_b32 m0, 30208
    s_nop 0
    buffer_load_dwordx4 v4, s[40:43], s44 offen  lds
    s_waitcnt vmcnt(2)
    s_mov_b32 s44, 180224
    s_mov_b32 m0, 31232
    s_nop 0
    buffer_load_dwordx4 v4, s[40:43], s44 offen  lds
    s_waitcnt vmcnt(2)
    s_mov_b32 s44, 188416
    s_mov_b32 m0, 32256
    s_nop 0
    buffer_load_dwordx4 v4, s[40:43], s44 offen  lds
    s_waitcnt vmcnt(2)
    s_mov_b32 s44, 196608
    s_mov_b32 m0, 33280
    s_nop 0
    buffer_load_dwordx4 v4, s[40:43], s44 offen  lds
    s_waitcnt vmcnt(2)
    s_mov_b32 s44, 204800
    s_mov_b32 m0, 34304
    s_nop 0
    buffer_load_dwordx4 v4, s[40:43], s44 offen  lds
    s_waitcnt vmcnt(2)
    s_mov_b32 s44, 212992
    s_mov_b32 m0, 35328
    s_nop 0
    buffer_load_dwordx4 v4, s[40:43], s44 offen  lds
    s_waitcnt vmcnt(2)
    s_mov_b32 s44, 221184
    s_mov_b32 m0, 36352
    s_nop 0
    buffer_load_dwordx4 v4, s[40:43], s44 offen  lds
    s_add_u32 m0, s34, 0
    s_mov_b32 s63, 0
    buffer_load_dwordx4 v37, s[48:51], s63 offen  lds
    s_add_u32 m0, s34, 1024
    s_mov_b32 s63, 4096
    buffer_load_dwordx4 v37, s[48:51], s63 offen  lds
    s_waitcnt vmcnt(1) lgkmcnt(0)
    s_add_u32 m0, s34, 2048
    s_mov_b32 s63, 8192
    buffer_load_dwordx4 v37, s[48:51], s63 offen  lds
    s_waitcnt vmcnt(1) lgkmcnt(0)
    s_add_u32 m0, s34, 3072
    s_mov_b32 s63, 12288
    buffer_load_dwordx4 v37, s[48:51], s63 offen  lds
    s_waitcnt vmcnt(1) lgkmcnt(0)
    s_add_u32 m0, s34, 4096
    s_mov_b32 s63, 16384
    buffer_load_dwordx4 v37, s[48:51], s63 offen  lds
    s_waitcnt vmcnt(1) lgkmcnt(0)
    s_add_u32 m0, s34, 5120
    s_mov_b32 s63, 20480
    buffer_load_dwordx4 v37, s[48:51], s63 offen  lds
    ds_read_b64_tr_b16 v[128:129], v3 offset:0
    ds_read_b64_tr_b16 v[136:137], v3 offset:32
    ds_read_b64_tr_b16 v[144:145], v3 offset:64
    ds_read_b64_tr_b16 v[152:153], v3 offset:96
    ds_read_b64_tr_b16 v[160:161], v3 offset:128
    ds_read_b64_tr_b16 v[168:169], v3 offset:160
    ds_read_b64_tr_b16 v[176:177], v3 offset:192
    ds_read_b64_tr_b16 v[184:185], v3 offset:224
    s_waitcnt vmcnt(1) lgkmcnt(0)
    s_add_u32 m0, s34, 6144
    s_mov_b32 s63, 24576
    buffer_load_dwordx4 v37, s[48:51], s63 offen  lds
    s_waitcnt vmcnt(1) lgkmcnt(0)
    s_add_u32 m0, s34, 7168
    s_mov_b32 s63, 28672
    buffer_load_dwordx4 v37, s[48:51], s63 offen  lds
    s_waitcnt vmcnt(1) lgkmcnt(0)
    s_add_u32 m0, s34, 0
    s_mov_b32 s63, 32768
    buffer_load_dwordx4 v37, s[48:51], s63 offen  lds
    s_waitcnt vmcnt(1) lgkmcnt(0)
    s_add_u32 m0, s34, 1024
    s_mov_b32 s63, 36864
    buffer_load_dwordx4 v37, s[48:51], s63 offen  lds
    ds_read_b64_tr_b16 v[130:131], v3 offset:4096
    ds_read_b64_tr_b16 v[138:139], v3 offset:4128
    ds_read_b64_tr_b16 v[146:147], v3 offset:4160
    ds_read_b64_tr_b16 v[154:155], v3 offset:4192
    ds_read_b64_tr_b16 v[162:163], v3 offset:4224
    ds_read_b64_tr_b16 v[170:171], v3 offset:4256
    ds_read_b64_tr_b16 v[178:179], v3 offset:4288
    ds_read_b64_tr_b16 v[186:187], v3 offset:4320
    s_waitcnt vmcnt(1) lgkmcnt(0)
    s_add_u32 m0, s34, 2048
    s_mov_b32 s63, 40960
    buffer_load_dwordx4 v37, s[48:51], s63 offen  lds
    s_waitcnt vmcnt(1) lgkmcnt(0)
    s_add_u32 m0, s34, 3072
    s_mov_b32 s63, 45056
    buffer_load_dwordx4 v37, s[48:51], s63 offen  lds
    s_waitcnt vmcnt(1) lgkmcnt(0)
    s_add_u32 m0, s34, 4096
    s_mov_b32 s63, 49152
    buffer_load_dwordx4 v37, s[48:51], s63 offen  lds
    s_waitcnt vmcnt(1) lgkmcnt(0)
    s_add_u32 m0, s34, 5120
    s_mov_b32 s63, 53248
    buffer_load_dwordx4 v37, s[48:51], s63 offen  lds
    ds_read_b64_tr_b16 v[132:133], v3 offset:0
    ds_read_b64_tr_b16 v[140:141], v3 offset:32
    ds_read_b64_tr_b16 v[148:149], v3 offset:64
    ds_read_b64_tr_b16 v[156:157], v3 offset:96
    ds_read_b64_tr_b16 v[164:165], v3 offset:128
    ds_read_b64_tr_b16 v[172:173], v3 offset:160
    ds_read_b64_tr_b16 v[180:181], v3 offset:192
    ds_read_b64_tr_b16 v[188:189], v3 offset:224
    s_waitcnt vmcnt(1) lgkmcnt(0)
    s_add_u32 m0, s34, 6144
    s_mov_b32 s63, 57344
    buffer_load_dwordx4 v37, s[48:51], s63 offen  lds
    s_waitcnt vmcnt(1) lgkmcnt(0)
    s_add_u32 m0, s34, 7168
    s_mov_b32 s63, 61440
    buffer_load_dwordx4 v37, s[48:51], s63 offen  lds
    s_waitcnt vmcnt(0)
    ds_read_b64_tr_b16 v[134:135], v3 offset:4096
    ds_read_b64_tr_b16 v[142:143], v3 offset:4128
    ds_read_b64_tr_b16 v[150:151], v3 offset:4160
    ds_read_b64_tr_b16 v[158:159], v3 offset:4192
    ds_read_b64_tr_b16 v[166:167], v3 offset:4224
    ds_read_b64_tr_b16 v[174:175], v3 offset:4256
    ds_read_b64_tr_b16 v[182:183], v3 offset:4288
    ds_read_b64_tr_b16 v[190:191], v3 offset:4320
    s_waitcnt lgkmcnt(0)
    v_lshrrev_b32 v4, 5, v0
    v_mul_u32_u24 v4, 0x7000, v4
    v_and_b32 v28, 31, v0
    v_lshl_add_u32 v4, v28, 4, v4
    s_mul_i32 s45, s28, 3584
    s_add_u32 s45, s45, 1048576
L_pg:
    buffer_load_dwordx4 v[40:43], v4, s[52:55], s45 offen offset:0 sc1
    buffer_load_dwordx4 v[44:47], v4, s[52:55], s45 offen offset:512 sc1
    buffer_load_dwordx4 v[48:51], v4, s[52:55], s45 offen offset:1024 sc1
    buffer_load_dwordx4 v[52:55], v4, s[52:55], s45 offen offset:1536 sc1
    buffer_load_dwordx4 v[56:59], v4, s[52:55], s45 offen offset:2048 sc1
    buffer_load_dwordx4 v[60:63], v4, s[52:55], s45 offen offset:2560 sc1
    buffer_load_dwordx4 v[64:67], v4, s[52:55], s45 offen offset:3072 sc1
    s_waitcnt vmcnt(0)
    v_xor_b32 v40, v40, v32
    v_xor_b32 v41, v41, v33
    v_xor_b32 v42, v42, v34
    v_xor_b32 v43, v43, v35
    v_xor_b32 v44, v44, v32
    v_xor_b32 v45, v45, v33
    v_xor_b32 v46, v46, v34
    v_xor_b32 v47, v47, v35
    v_xor_b32 v48, v48, v32
    v_xor_b32 v49, v49, v33
    v_xor_b32 v50, v50, v34
    v_xor_b32 v51, v51, v35
    v_xor_b32 v52, v52, v32
    v_xor_b32 v53, v53, v33
    v_xor_b32 v54, v54, v34
    v_xor_b32 v55, v55, v35
    v_xor_b32 v56, v56, v32
    v_xor_b32 v57, v57, v33
    v_xor_b32 v58, v58, v34
    v_xor_b32 v59, v59, v35
    v_xor_b32 v60, v60, v32
    v_xor_b32 v61, v61, v33
    v_xor_b32 v62, v62, v34
    v_xor_b32 v63, v63, v35
    v_xor_b32 v64, v64, v32
    v_xor_b32 v65, v65, v33
    v_xor_b32 v66, v66, v34
    v_xor_b32 v67, v67, v35
    v_or_b32 v28, v40, v41
    v_or3_b32 v28, v28, v42, v43
    v_or3_b32 v28, v28, v44, v45
    v_or3_b32 v28, v28, v46, v47
    v_or3_b32 v28, v28, v48, v49
    v_or3_b32 v28, v28, v50, v51
    v_or3_b32 v28, v28, v52, v53
    v_or3_b32 v28, v28, v54, v55
    v_or3_b32 v28, v28, v56, v57
    v_or3_b32 v28, v28, v58, v59
    v_or3_b32 v28, v28, v60, v61
    v_or3_b32 v28, v28, v62, v63
    v_or3_b32 v28, v28, v64, v65
    v_or3_b32 v28, v28, v66, v67
    v_and_b32 v28, 0xffff, v28
    v_cmp_ne_u32 vcc, 0, v28
    s_nop 4
    s_cbranch_vccz L_pg_ok
    s_sleep 32
    s_sub_u32 s62, s62, 1
    s_cmp_gt_i32 s62, 0
    s_cbranch_scc1 L_pg
L_pg_ok:
    v_mov_b32 v68, v64
    v_mov_b32 v69, v65
    v_mov_b32 v70, v66
    v_mov_b32 v71, v67
    v_lshlrev_b32 v28, 1, v0
    v_permlane32_swap_b32 v40, v44
    v_permlane32_swap_b32 v41, v45
    v_permlane32_swap_b32 v42, v46
    v_permlane32_swap_b32 v43, v47
    v_max_f32 v40, 0, v40
    v_max_f32 v41, 0, v41
    v_max_f32 v42, 0, v42
    v_max_f32 v43, 0, v43
    v_mul_f32 v40, v40, v44
    v_mul_f32 v41, v41, v45
    v_mul_f32 v42, v42, v46
    v_mul_f32 v43, v43, v47
    v_cvt_pk_bf16_f32 v40, v40, v40
    v_cvt_pk_bf16_f32 v41, v41, v41
    v_cvt_pk_bf16_f32 v42, v42, v42
    v_cvt_pk_bf16_f32 v43, v43, v43
    ds_write_b16 v28, v40 offset:4608
    ds_write_b16 v28, v41 offset:5120
    ds_write_b16 v28, v42 offset:5632
    ds_write_b16 v28, v43 offset:6144
    v_permlane32_swap_b32 v48, v52
    v_permlane32_swap_b32 v49, v53
    v_permlane32_swap_b32 v50, v54
    v_permlane32_swap_b32 v51, v55
    v_max_f32 v48, 0, v48
    v_max_f32 v49, 0, v49
    v_max_f32 v50, 0, v50
    v_max_f32 v51, 0, v51
    v_mul_f32 v48, v48, v52
    v_mul_f32 v49, v49, v53
    v_mul_f32 v50, v50, v54
    v_mul_f32 v51, v51, v55
    v_cvt_pk_bf16_f32 v48, v48, v48
    v_cvt_pk_bf16_f32 v49, v49, v49
    v_cvt_pk_bf16_f32 v50, v50, v50
    v_cvt_pk_bf16_f32 v51, v51, v51
    ds_write_b16 v28, v48 offset:4736
    ds_write_b16 v28, v49 offset:5248
    ds_write_b16 v28, v50 offset:5760
    ds_write_b16 v28, v51 offset:6272
    s_waitcnt lgkmcnt(0)
    v_permlane32_swap_b32 v56, v60
    v_permlane32_swap_b32 v57, v61
    v_permlane32_swap_b32 v58, v62
    v_permlane32_swap_b32 v59, v63
    v_max_f32 v56, 0, v56
    v_max_f32 v57, 0, v57
    v_max_f32 v58, 0, v58
    v_max_f32 v59, 0, v59
    v_mul_f32 v56, v56, v60
    v_mul_f32 v57, v57, v61
    v_mul_f32 v58, v58, v62
    v_mul_f32 v59, v59, v63
    v_cvt_pk_bf16_f32 v56, v56, v56
    v_cvt_pk_bf16_f32 v57, v57, v57
    v_cvt_pk_bf16_f32 v58, v58, v58
    v_cvt_pk_bf16_f32 v59, v59, v59
    ds_write_b16 v28, v56 offset:4864
    ds_write_b16 v28, v57 offset:5376
    ds_write_b16 v28, v58 offset:5888
    ds_write_b16 v28, v59 offset:6400
    v_permlane32_swap_b32 v64, v68
    v_permlane32_swap_b32 v65, v69
    v_permlane32_swap_b32 v66, v70
    v_permlane32_swap_b32 v67, v71
    v_max_f32 v64, 0, v64
    v_max_f32 v65, 0, v65
    v_max_f32 v66, 0, v66
    v_max_f32 v67, 0, v67
    v_mul_f32 v64, v64, v68
    v_mul_f32 v65, v65, v69
    v_mul_f32 v66, v66, v70
    v_mul_f32 v67, v67, v71
    v_cvt_pk_bf16_f32 v64, v64, v64
    v_cvt_pk_bf16_f32 v65, v65, v65
    v_cvt_pk_bf16_f32 v66, v66, v66
    v_cvt_pk_bf16_f32 v67, v67, v67
    ds_write_b16 v28, v64 offset:4992
    ds_write_b16 v28, v65 offset:5504
    ds_write_b16 v28, v66 offset:6016
    ds_write_b16 v28, v67 offset:6528
    s_waitcnt lgkmcnt(0)
    v_lshlrev_b32 v7, 9, v7
    v_lshl_add_u32 v7, v1, 4, v7
    ds_read_b64_tr_b16 v[56:57], v6 offset:8704
    ds_read_b64_tr_b16 v[58:59], v6 offset:9216
    ds_read_b64_tr_b16 v[60:61], v6 offset:8736
    ds_read_b64_tr_b16 v[62:63], v6 offset:9248
    ds_read_b64_tr_b16 v[64:65], v6 offset:8768
    ds_read_b64_tr_b16 v[66:67], v6 offset:9280
    ds_read_b64_tr_b16 v[68:69], v6 offset:8800
    ds_read_b64_tr_b16 v[70:71], v6 offset:9312
    ds_read_b128 v[72:75], v7 offset:4608
    s_waitcnt lgkmcnt(0)
    v_mfma_f32_16x16x32_bf16 v[96:99], v[72:75], v[56:59], 0
    v_mfma_f32_16x16x32_bf16 v[100:103], v[72:75], v[60:63], 0
    v_mfma_f32_16x16x32_bf16 v[104:107], v[72:75], v[64:67], 0
    v_mfma_f32_16x16x32_bf16 v[108:111], v[72:75], v[68:71], 0
    s_nop 3
    ds_read_b64_tr_b16 v[56:57], v6 offset:12800
    ds_read_b64_tr_b16 v[58:59], v6 offset:13312
    ds_read_b64_tr_b16 v[60:61], v6 offset:12832
    ds_read_b64_tr_b16 v[62:63], v6 offset:13344
    ds_read_b64_tr_b16 v[64:65], v6 offset:12864
    ds_read_b64_tr_b16 v[66:67], v6 offset:13376
    ds_read_b64_tr_b16 v[68:69], v6 offset:12896
    ds_read_b64_tr_b16 v[70:71], v6 offset:13408
    ds_read_b128 v[72:75], v7 offset:4672
    s_waitcnt lgkmcnt(0)
    v_mfma_f32_16x16x32_bf16 v[96:99], v[72:75], v[56:59], v[96:99]
    v_mfma_f32_16x16x32_bf16 v[100:103], v[72:75], v[60:63], v[100:103]
    v_mfma_f32_16x16x32_bf16 v[104:107], v[72:75], v[64:67], v[104:107]
    v_mfma_f32_16x16x32_bf16 v[108:111], v[72:75], v[68:71], v[108:111]
    s_nop 3
    ds_read_b64_tr_b16 v[56:57], v6 offset:16896
    ds_read_b64_tr_b16 v[58:59], v6 offset:17408
    ds_read_b64_tr_b16 v[60:61], v6 offset:16928
    ds_read_b64_tr_b16 v[62:63], v6 offset:17440
    ds_read_b64_tr_b16 v[64:65], v6 offset:16960
    ds_read_b64_tr_b16 v[66:67], v6 offset:17472
    ds_read_b64_tr_b16 v[68:69], v6 offset:16992
    ds_read_b64_tr_b16 v[70:71], v6 offset:17504
    ds_read_b128 v[72:75], v7 offset:4736
    s_waitcnt lgkmcnt(0)
    v_mfma_f32_16x16x32_bf16 v[96:99], v[72:75], v[56:59], v[96:99]
    v_mfma_f32_16x16x32_bf16 v[100:103], v[72:75], v[60:63], v[100:103]
    v_mfma_f32_16x16x32_bf16 v[104:107], v[72:75], v[64:67], v[104:107]
    v_mfma_f32_16x16x32_bf16 v[108:111], v[72:75], v[68:71], v[108:111]
    s_nop 3
    ds_read_b64_tr_b16 v[56:57], v6 offset:20992
    ds_read_b64_tr_b16 v[58:59], v6 offset:21504
    ds_read_b64_tr_b16 v[60:61], v6 offset:21024
    ds_read_b64_tr_b16 v[62:63], v6 offset:21536
    ds_read_b64_tr_b16 v[64:65], v6 offset:21056
    ds_read_b64_tr_b16 v[66:67], v6 offset:21568
    ds_read_b64_tr_b16 v[68:69], v6 offset:21088
    ds_read_b64_tr_b16 v[70:71], v6 offset:21600
    ds_read_b128 v[72:75], v7 offset:4800
    s_waitcnt lgkmcnt(0)
    v_mfma_f32_16x16x32_bf16 v[96:99], v[72:75], v[56:59], v[96:99]
    v_mfma_f32_16x16x32_bf16 v[100:103], v[72:75], v[60:63], v[100:103]
    v_mfma_f32_16x16x32_bf16 v[104:107], v[72:75], v[64:67], v[104:107]
    v_mfma_f32_16x16x32_bf16 v[108:111], v[72:75], v[68:71], v[108:111]
    s_nop 3
    ds_read_b64_tr_b16 v[56:57], v6 offset:25088
    ds_read_b64_tr_b16 v[58:59], v6 offset:25600
    ds_read_b64_tr_b16 v[60:61], v6 offset:25120
    ds_read_b64_tr_b16 v[62:63], v6 offset:25632
    ds_read_b64_tr_b16 v[64:65], v6 offset:25152
    ds_read_b64_tr_b16 v[66:67], v6 offset:25664
    ds_read_b64_tr_b16 v[68:69], v6 offset:25184
    ds_read_b64_tr_b16 v[70:71], v6 offset:25696
    ds_read_b128 v[72:75], v7 offset:4864
    s_waitcnt lgkmcnt(0)
    v_mfma_f32_16x16x32_bf16 v[96:99], v[72:75], v[56:59], v[96:99]
    v_mfma_f32_16x16x32_bf16 v[100:103], v[72:75], v[60:63], v[100:103]
    v_mfma_f32_16x16x32_bf16 v[104:107], v[72:75], v[64:67], v[104:107]
    v_mfma_f32_16x16x32_bf16 v[108:111], v[72:75], v[68:71], v[108:111]
    s_nop 3
    ds_read_b64_tr_b16 v[56:57], v6 offset:29184
    ds_read_b64_tr_b16 v[58:59], v6 offset:29696
    ds_read_b64_tr_b16 v[60:61], v6 offset:29216
    ds_read_b64_tr_b16 v[62:63], v6 offset:29728
    ds_read_b64_tr_b16 v[64:65], v6 offset:29248
    ds_read_b64_tr_b16 v[66:67], v6 offset:29760
    ds_read_b64_tr_b16 v[68:69], v6 offset:29280
    ds_read_b64_tr_b16 v[70:71], v6 offset:29792
    ds_read_b128 v[72:75], v7 offset:4928
    s_waitcnt lgkmcnt(0)
    v_mfma_f32_16x16x32_bf16 v[96:99], v[72:75], v[56:59], v[96:99]
    v_mfma_f32_16x16x32_bf16 v[100:103], v[72:75], v[60:63], v[100:103]
    v_mfma_f32_16x16x32_bf16 v[104:107], v[72:75], v[64:67], v[104:107]
    v_mfma_f32_16x16x32_bf16 v[108:111], v[72:75], v[68:71], v[108:111]
    s_nop 3
    ds_read_b64_tr_b16 v[56:57], v6 offset:33280
    ds_read_b64_tr_b16 v[58:59], v6 offset:33792
    ds_read_b64_tr_b16 v[60:61], v6 offset:33312
    ds_read_b64_tr_b16 v[62:63], v6 offset:33824
    ds_read_b64_tr_b16 v[64:65], v6 offset:33344
    ds_read_b64_tr_b16 v[66:67], v6 offset:33856
    ds_read_b64_tr_b16 v[68:69], v6 offset:33376
    ds_read_b64_tr_b16 v[70:71], v6 offset:33888
    ds_read_b128 v[72:75], v7 offset:4992
    s_waitcnt lgkmcnt(0)
    v_mfma_f32_16x16x32_bf16 v[96:99], v[72:75], v[56:59], v[96:99]
    v_mfma_f32_16x16x32_bf16 v[100:103], v[72:75], v[60:63], v[100:103]
    v_mfma_f32_16x16x32_bf16 v[104:107], v[72:75], v[64:67], v[104:107]
    v_mfma_f32_16x16x32_bf16 v[108:111], v[72:75], v[68:71], v[108:111]
    s_nop 3
    s_nop 1
    v_mov_b32_dpp v96, v100 quad_perm:[0,1,2,3] row_mask:0x2 bank_mask:0xf
    v_mov_b32_dpp v97, v101 quad_perm:[0,1,2,3] row_mask:0x2 bank_mask:0xf
    v_mov_b32_dpp v98, v102 quad_perm:[0,1,2,3] row_mask:0x2 bank_mask:0xf
    v_mov_b32_dpp v99, v103 quad_perm:[0,1,2,3] row_mask:0x2 bank_mask:0xf
    v_mov_b32_dpp v96, v104 quad_perm:[0,1,2,3] row_mask:0x4 bank_mask:0xf
    v_mov_b32_dpp v97, v105 quad_perm:[0,1,2,3] row_mask:0x4 bank_mask:0xf
    v_mov_b32_dpp v98, v106 quad_perm:[0,1,2,3] row_mask:0x4 bank_mask:0xf
    v_mov_b32_dpp v99, v107 quad_perm:[0,1,2,3] row_mask:0x4 bank_mask:0xf
    v_mov_b32_dpp v96, v108 quad_perm:[0,1,2,3] row_mask:0x8 bank_mask:0xf
    v_mov_b32_dpp v97, v109 quad_perm:[0,1,2,3] row_mask:0x8 bank_mask:0xf
    v_mov_b32_dpp v98, v110 quad_perm:[0,1,2,3] row_mask:0x8 bank_mask:0xf
    v_mov_b32_dpp v99, v111 quad_perm:[0,1,2,3] row_mask:0x8 bank_mask:0xf
    v_and_or_b32 v96, v96, s75, v32
    v_and_or_b32 v97, v97, s75, v33
    v_and_or_b32 v98, v98, s75, v34
    v_and_or_b32 v99, v99, s75, v35
    buffer_store_dwordx4 v[96:99], v5, s[52:55], s46 offen sc1
    s_add_u32 m0, s34, 0
    s_mov_b32 s63, 65536
    buffer_load_dwordx4 v37, s[48:51], s63 offen  lds
    s_add_u32 m0, s34, 1024
    s_mov_b32 s63, 69632
    buffer_load_dwordx4 v37, s[48:51], s63 offen  lds
    s_waitcnt vmcnt(1) lgkmcnt(0)
    s_add_u32 m0, s34, 2048
    s_mov_b32 s63, 73728
    buffer_load_dwordx4 v37, s[48:51], s63 offen  lds
    s_waitcnt vmcnt(1) lgkmcnt(0)
    s_add_u32 m0, s34, 3072
    s_mov_b32 s63, 77824
    buffer_load_dwordx4 v37, s[48:51], s63 offen  lds
    s_waitcnt vmcnt(1) lgkmcnt(0)
    s_add_u32 m0, s34, 4096
    s_mov_b32 s63, 81920
    buffer_load_dwordx4 v37, s[48:51], s63 offen  lds
    s_waitcnt vmcnt(1) lgkmcnt(0)
    s_add_u32 m0, s34, 5120
    s_mov_b32 s63, 86016
    buffer_load_dwordx4 v37, s[48:51], s63 offen  lds
    ds_read_b64_tr_b16 v[192:193], v3 offset:0
    ds_read_b64_tr_b16 v[200:201], v3 offset:32
    ds_read_b64_tr_b16 v[208:209], v3 offset:64
    ds_read_b64_tr_b16 v[216:217], v3 offset:96
    ds_read_b64_tr_b16 v[224:225], v3 offset:128
    ds_read_b64_tr_b16 v[232:233], v3 offset:160
    ds_read_b64_tr_b16 v[240:241], v3 offset:192
    ds_read_b64_tr_b16 v[248:249], v3 offset:224
    s_waitcnt vmcnt(1) lgkmcnt(0)
    s_add_u32 m0, s34, 6144
    s_mov_b32 s63, 90112
    buffer_load_dwordx4 v37, s[48:51], s63 offen  lds
    s_waitcnt vmcnt(1) lgkmcnt(0)
    s_add_u32 m0, s34, 7168
    s_mov_b32 s63, 94208
    buffer_load_dwordx4 v37, s[48:51], s63 offen  lds
    s_waitcnt vmcnt(1) lgkmcnt(0)
    s_add_u32 m0, s34, 0
    s_mov_b32 s63, 98304
    buffer_load_dwordx4 v37, s[48:51], s63 offen  lds
    s_waitcnt vmcnt(1) lgkmcnt(0)
    s_add_u32 m0, s34, 1024
    s_mov_b32 s63, 102400
    buffer_load_dwordx4 v37, s[48:51], s63 offen  lds
    ds_read_b64_tr_b16 v[194:195], v3 offset:4096
    ds_read_b64_tr_b16 v[202:203], v3 offset:4128
    ds_read_b64_tr_b16 v[210:211], v3 offset:4160
    ds_read_b64_tr_b16 v[218:219], v3 offset:4192
    ds_read_b64_tr_b16 v[226:227], v3 offset:4224
    ds_read_b64_tr_b16 v[234:235], v3 offset:4256
    ds_read_b64_tr_b16 v[242:243], v3 offset:4288
    ds_read_b64_tr_b16 v[250:251], v3 offset:4320
    s_waitcnt vmcnt(1) lgkmcnt(0)
    s_add_u32 m0, s34, 2048
    s_mov_b32 s63, 106496
    buffer_load_dwordx4 v37, s[48:51], s63 offen  lds
    s_waitcnt vmcnt(1) lgkmcnt(0)
    s_add_u32 m0, s34, 3072
    s_mov_b32 s63, 110592
    buffer_load_dwordx4 v37, s[48:51], s63 offen  lds
    s_waitcnt vmcnt(1) lgkmcnt(0)
    s_add_u32 m0, s34, 4096
    s_mov_b32 s63, 114688
    buffer_load_dwordx4 v37, s[48:51], s63 offen  lds
    s_waitcnt vmcnt(1) lgkmcnt(0)
    s_add_u32 m0, s34, 5120
    s_mov_b32 s63, 118784
    buffer_load_dwordx4 v37, s[48:51], s63 offen  lds
    ds_read_b64_tr_b16 v[196:197], v3 offset:0
    ds_read_b64_tr_b16 v[204:205], v3 offset:32
    ds_read_b64_tr_b16 v[212:213], v3 offset:64
    ds_read_b64_tr_b16 v[220:221], v3 offset:96
    ds_read_b64_tr_b16 v[228:229], v3 offset:128
    ds_read_b64_tr_b16 v[236:237], v3 offset:160
    ds_read_b64_tr_b16 v[244:245], v3 offset:192
    ds_read_b64_tr_b16 v[252:253], v3 offset:224
    s_waitcnt vmcnt(1) lgkmcnt(0)
    s_add_u32 m0, s34, 6144
    s_mov_b32 s63, 122880
    buffer_load_dwordx4 v37, s[48:51], s63 offen  lds
    s_waitcnt vmcnt(1) lgkmcnt(0)
    s_add_u32 m0, s34, 7168
    s_mov_b32 s63, 126976
    buffer_load_dwordx4 v37, s[48:51], s63 offen  lds
    s_waitcnt vmcnt(0)
    ds_read_b64_tr_b16 v[198:199], v3 offset:4096
    ds_read_b64_tr_b16 v[206:207], v3 offset:4128
    ds_read_b64_tr_b16 v[214:215], v3 offset:4160
    ds_read_b64_tr_b16 v[222:223], v3 offset:4192
    ds_read_b64_tr_b16 v[230:231], v3 offset:4224
    ds_read_b64_tr_b16 v[238:239], v3 offset:4256
    ds_read_b64_tr_b16 v[246:247], v3 offset:4288
    ds_read_b64_tr_b16 v[254:255], v3 offset:4320
    s_waitcnt lgkmcnt(0)
    s_branch L_tail
L_H123:
    s_add_u32 m0, s34, 0
    s_mov_b32 s63, 0
    buffer_load_dwordx4 v37, s[48:51], s63 offen  lds
    s_waitcnt vmcnt(0) lgkmcnt(0)
    s_add_u32 m0, s34, 1024
    s_mov_b32 s63, 4096
    buffer_load_dwordx4 v37, s[48:51], s63 offen  lds
    s_waitcnt vmcnt(0) lgkmcnt(0)
    s_add_u32 m0, s34, 2048
    s_mov_b32 s63, 8192
    buffer_load_dwordx4 v37, s[48:51], s63 offen  lds
    s_waitcnt vmcnt(0) lgkmcnt(0)
    s_add_u32 m0, s34, 3072
    s_mov_b32 s63, 12288
    buffer_load_dwordx4 v37, s[48:51], s63 offen  lds
    s_waitcnt vmcnt(0) lgkmcnt(0)
    s_add_u32 m0, s34, 4096
    s_mov_b32 s63, 16384
    buffer_load_dwordx4 v37, s[48:51], s63 offen  lds
    ds_read_b64_tr_b16 v[128:129], v3 offset:0
    ds_read_b64_tr_b16 v[136:137], v3 offset:32
    ds_read_b64_tr_b16 v[144:145], v3 offset:64
    ds_read_b64_tr_b16 v[152:153], v3 offset:96
    ds_read_b64_tr_b16 v[160:161], v3 offset:128
    ds_read_b64_tr_b16 v[168:169], v3 offset:160
    ds_read_b64_tr_b16 v[176:177], v3 offset:192
    ds_read_b64_tr_b16 v[184:185], v3 offset:224
    s_waitcnt vmcnt(0) lgkmcnt(0)
    s_add_u32 m0, s34, 5120
    s_mov_b32 s63, 20480
    buffer_load_dwordx4 v37, s[48:51], s63 offen  lds
    s_waitcnt vmcnt(0) lgkmcnt(0)
    s_add_u32 m0, s34, 6144
    s_mov_b32 s63, 24576
    buffer_load_dwordx4 v37, s[48:51], s63 offen  lds
    s_waitcnt vmcnt(0) lgkmcnt(0)
    s_add_u32 m0, s34, 7168
    s_mov_b32 s63, 28672
    buffer_load_dwordx4 v37, s[48:51], s63 offen  lds
    s_waitcnt vmcnt(0) lgkmcnt(0)
    s_add_u32 m0, s34, 0
    s_mov_b32 s63, 32768
    buffer_load_dwordx4 v37, s[48:51], s63 offen  lds
    ds_read_b64_tr_b16 v[130:131], v3 offset:4096
    ds_read_b64_tr_b16 v[138:139], v3 offset:4128
    ds_read_b64_tr_b16 v[146:147], v3 offset:4160
    ds_read_b64_tr_b16 v[154:155], v3 offset:4192
    ds_read_b64_tr_b16 v[162:163], v3 offset:4224
    ds_read_b64_tr_b16 v[170:171], v3 offset:4256
    ds_read_b64_tr_b16 v[178:179], v3 offset:4288
    ds_read_b64_tr_b16 v[186:187], v3 offset:4320
    s_waitcnt vmcnt(0) lgkmcnt(0)
    s_add_u32 m0, s34, 1024
    s_mov_b32 s63, 36864
    buffer_load_dwordx4 v37, s[48:51], s63 offen  lds
    s_waitcnt vmcnt(0) lgkmcnt(0)
    s_add_u32 m0, s34, 2048
    s_mov_b32 s63, 40960
    buffer_load_dwordx4 v37, s[48:51], s63 offen  lds
    s_waitcnt vmcnt(0) lgkmcnt(0)
    s_add_u32 m0, s34, 3072
    s_mov_b32 s63, 45056
    buffer_load_dwordx4 v37, s[48:51], s63 offen  lds
    s_waitcnt vmcnt(0) lgkmcnt(0)
    s_add_u32 m0, s34, 4096
    s_mov_b32 s63, 49152
    buffer_load_dwordx4 v37, s[48:51], s63 offen  lds
    ds_read_b64_tr_b16 v[132:133], v3 offset:0
    ds_read_b64_tr_b16 v[140:141], v3 offset:32
    ds_read_b64_tr_b16 v[148:149], v3 offset:64
    ds_read_b64_tr_b16 v[156:157], v3 offset:96
    ds_read_b64_tr_b16 v[164:165], v3 offset:128
    ds_read_b64_tr_b16 v[172:173], v3 offset:160
    ds_read_b64_tr_b16 v[180:181], v3 offset:192
    ds_read_b64_tr_b16 v[188:189], v3 offset:224
    s_waitcnt vmcnt(0) lgkmcnt(0)
    s_add_u32 m0, s34, 5120
    s_mov_b32 s63, 53248
    buffer_load_dwordx4 v37, s[48:51], s63 offen  lds
    s_waitcnt vmcnt(0) lgkmcnt(0)
    s_add_u32 m0, s34, 6144
    s_mov_b32 s63, 57344
    buffer_load_dwordx4 v37, s[48:51], s63 offen  lds
    s_waitcnt vmcnt(0) lgkmcnt(0)
    s_add_u32 m0, s34, 7168
    s_mov_b32 s63, 61440
    buffer_load_dwordx4 v37, s[48:51], s63 offen  lds
    s_waitcnt vmcnt(1) lgkmcnt(0)
    s_add_u32 m0, s34, 0
    s_mov_b32 s63, 65536
    buffer_load_dwordx4 v37, s[48:51], s63 offen  lds
    s_waitcnt vmcnt(1) lgkmcnt(0)
    s_add_u32 m0, s34, 1024
    s_mov_b32 s63, 69632
    buffer_load_dwordx4 v37, s[48:51], s63 offen  lds
    ds_read_b64_tr_b16 v[134:135], v3 offset:4096
    ds_read_b64_tr_b16 v[142:143], v3 offset:4128
    ds_read_b64_tr_b16 v[150:151], v3 offset:4160
    ds_read_b64_tr_b16 v[158:159], v3 offset:4192
    ds_read_b64_tr_b16 v[166:167], v3 offset:4224
    ds_read_b64_tr_b16 v[174:175], v3 offset:4256
    ds_read_b64_tr_b16 v[182:183], v3 offset:4288
    ds_read_b64_tr_b16 v[190:191], v3 offset:4320
    s_waitcnt vmcnt(1) lgkmcnt(0)
    s_add_u32 m0, s34, 2048
    s_mov_b32 s63, 73728
    buffer_load_dwordx4 v37, s[48:51], s63 offen  lds
    s_waitcnt vmcnt(1) lgkmcnt(0)
    s_add_u32 m0, s34, 3072
    s_mov_b32 s63, 77824
    buffer_load_dwordx4 v37, s[48:51], s63 offen  lds
    s_waitcnt vmcnt(1) lgkmcnt(0)
    s_add_u32 m0, s34, 4096
    s_mov_b32 s63, 81920
    buffer_load_dwordx4 v37, s[48:51], s63 offen  lds
    s_waitcnt vmcnt(1) lgkmcnt(0)
    s_add_u32 m0, s34, 5120
    s_mov_b32 s63, 86016
    buffer_load_dwordx4 v37, s[48:51], s63 offen  lds
    ds_read_b64_tr_b16 v[192:193], v3 offset:0
    ds_read_b64_tr_b16 v[200:201], v3 offset:32
    ds_read_b64_tr_b16 v[208:209], v3 offset:64
    ds_read_b64_tr_b16 v[216:217], v3 offset:96
    ds_read_b64_tr_b16 v[224:225], v3 offset:128
    ds_read_b64_tr_b16 v[232:233], v3 offset:160
    ds_read_b64_tr_b16 v[240:241], v3 offset:192
    ds_read_b64_tr_b16 v[248:249], v3 offset:224
    s_waitcnt vmcnt(0)
    s_waitcnt lgkmcnt(0)
    s_cmp_eq_u32 s35, 2
    s_cbranch_scc1 L_H2
    s_add_u32 m0, s34, 6144
    s_mov_b32 s63, 90112
    buffer_load_dwordx4 v37, s[48:51], s63 offen  lds
    s_add_u32 m0, s34, 7168
    s_mov_b32 s63, 94208
    buffer_load_dwordx4 v37, s[48:51], s63 offen  lds
    s_waitcnt vmcnt(1) lgkmcnt(0)
    s_add_u32 m0, s34, 0
    s_mov_b32 s63, 98304
    buffer_load_dwordx4 v37, s[48:51], s63 offen  lds
    s_waitcnt vmcnt(1) lgkmcnt(0)
    s_add_u32 m0, s34, 1024
    s_mov_b32 s63, 102400
    buffer_load_dwordx4 v37, s[48:51], s63 offen  lds
    ds_read_b64_tr_b16 v[194:195], v3 offset:4096
    ds_read_b64_tr_b16 v[202:203], v3 offset:4128
    ds_read_b64_tr_b16 v[210:211], v3 offset:4160
    ds_read_b64_tr_b16 v[218:219], v3 offset:4192
    ds_read_b64_tr_b16 v[226:227], v3 offset:4224
    ds_read_b64_tr_b16 v[234:235], v3 offset:4256
    ds_read_b64_tr_b16 v[242:243], v3 offset:4288
    ds_read_b64_tr_b16 v[250:251], v3 offset:4320
    s_waitcnt vmcnt(1) lgkmcnt(0)
    s_add_u32 m0, s34, 2048
    s_mov_b32 s63, 106496
    buffer_load_dwordx4 v37, s[48:51], s63 offen  lds
    s_waitcnt vmcnt(1) lgkmcnt(0)
    s_add_u32 m0, s34, 3072
    s_mov_b32 s63, 110592
    buffer_load_dwordx4 v37, s[48:51], s63 offen  lds
    s_waitcnt vmcnt(1) lgkmcnt(0)
    s_add_u32 m0, s34, 4096
    s_mov_b32 s63, 114688
    buffer_load_dwordx4 v37, s[48:51], s63 offen  lds
    s_waitcnt vmcnt(1) lgkmcnt(0)
    s_add_u32 m0, s34, 5120
    s_mov_b32 s63, 118784
    buffer_load_dwordx4 v37, s[48:51], s63 offen  lds
    ds_read_b64_tr_b16 v[196:197], v3 offset:0
    ds_read_b64_tr_b16 v[204:205], v3 offset:32
    ds_read_b64_tr_b16 v[212:213], v3 offset:64
    ds_read_b64_tr_b16 v[220:221], v3 offset:96
    ds_read_b64_tr_b16 v[228:229], v3 offset:128
    ds_read_b64_tr_b16 v[236:237], v3 offset:160
    ds_read_b64_tr_b16 v[244:245], v3 offset:192
    ds_read_b64_tr_b16 v[252:253], v3 offset:224
    s_waitcnt vmcnt(1) lgkmcnt(0)
    s_add_u32 m0, s34, 6144
    s_mov_b32 s63, 122880
    buffer_load_dwordx4 v37, s[48:51], s63 offen  lds
    s_waitcnt vmcnt(1) lgkmcnt(0)
    s_add_u32 m0, s34, 7168
    s_mov_b32 s63, 126976
    buffer_load_dwordx4 v37, s[48:51], s63 offen  lds
    s_waitcnt vmcnt(0)
    ds_read_b64_tr_b16 v[198:199], v3 offset:4096
    ds_read_b64_tr_b16 v[206:207], v3 offset:4128
    ds_read_b64_tr_b16 v[214:215], v3 offset:4160
    ds_read_b64_tr_b16 v[222:223], v3 offset:4192
    ds_read_b64_tr_b16 v[230:231], v3 offset:4224
    ds_read_b64_tr_b16 v[238:239], v3 offset:4256
    ds_read_b64_tr_b16 v[246:247], v3 offset:4288
    ds_read_b64_tr_b16 v[254:255], v3 offset:4320
    s_waitcnt lgkmcnt(0)
    s_cmp_eq_u32 s35, 1
    s_cbranch_scc1 L_H1
    s_cmp_lg_u32 s2, 0xff
    s_cbranch_scc1 L_tail
    v_lshlrev_b32 v4, 7, v0
    s_add_u32 s64, s74, 0
    s_add_u32 s65, s74, 37
    s_add_u32 s66, s74, 74
    s_add_u32 s67, s74, 111
    s_mov_b32 s44, 0
L_pe:
    buffer_load_dwordx4 v[40:43], v4, s[52:55], s44 offen offset:3072 sc1
    s_waitcnt vmcnt(0)
    v_xor_b32 v40, s64, v40
    v_xor_b32 v41, s65, v41
    v_xor_b32 v42, s66, v42
    v_xor_b32 v43, s67, v43
    v_or_b32 v28, v40, v41
    v_or3_b32 v28, v28, v42, v43
    v_and_b32 v28, 0xff, v28
    v_cmp_ne_u32 vcc, 0, v28
    s_nop 4
    s_cbranch_vccz L_pe_ok
    s_sleep 16
    s_sub_u32 s62, s62, 1
    s_cmp_gt_i32 s62, 0
    s_cbranch_scc1 L_pe
L_pe_ok:
    s_add_u32 s44, s44, 8192
    s_cmp_lt_u32 s44, 32768
    s_cbranch_scc1 L_pe
    s_mov_b64 exec, 1
    v_mov_b32 v28, s74
    s_mov_b32 s45, 1179648
    buffer_store_dword v28, off, s[52:55], s45 sc1
    s_mov_b64 exec, -1
    s_branch L_tail
L_H1:
    v_and_b32 v7, 7, v0
    v_lshrrev_b32 v36, 3, v0
    s_lshl_b32 s45, s28, 7
    s_and_b32 s46, s29, 7
    s_lshl_b32 s46, s46, 4
    s_add_u32 s46, s46, s45
    s_lshr_b32 s47, s29, 3
    s_lshl_b32 s72, s47, 10
    s_add_u32 s72, s72, s46
    v_lshlrev_b32 v33, 1, v7
    buffer_load_ushort v34, v33, s[36:39], s72 offen
    v_and_b32 v6, 1, v0
    v_lshl_add_u32 v6, v6, 2, s47
    v_mul_u32_u24 v39, 37, v6
    v_add_u32 v39, s74, v39
    v_and_b32 v39, 0xff, v39
    v_lshlrev_b32 v4, 10, v36
    v_lshl_add_u32 v4, v7, 4, v4
    s_lshl_b32 s44, s28, 13
    s_and_b32 s45, s29, 7
    s_lshl_b32 s45, s45, 7
    s_add_u32 s44, s44, s45
    s_lshl_b32 s45, s47, 2
    s_add_u32 s44, s44, s45
    s_add_u32 s44, s44, 1114112
L_pd:
    buffer_load_dword v40, v4, s[52:55], s44 offen sc1
    s_waitcnt vmcnt(0)
    v_xor_b32 v40, v40, v39
    v_and_b32 v28, 0xff, v40
    v_cmp_ne_u32 vcc, 0, v28
    s_nop 4
    s_cbranch_vccz L_pd_ok
    s_sleep 16
    s_sub_u32 s62, s62, 1
    s_cmp_gt_i32 s62, 0
    s_cbranch_scc1 L_pd
L_pd_ok:
    v_lshlrev_b32 v34, 16, v34
    v_add_f32_dpp v40, v40, v40 row_ror:8 row_mask:0xf bank_mask:0xf
    v_mov_b32 v41, v40
    s_nop 1
    v_permlane16_swap_b32 v40, v41
    v_add_f32 v40, v40, v41
    v_mov_b32 v41, v40
    s_nop 1
    v_permlane32_swap_b32 v40, v41
    v_add_f32 v40, v40, v41
    v_cvt_pk_bf16_f32 v40, 0, v40
    v_mul_f32 v41, 0xbfb8aa3b, v40
    v_exp_f32 v41, v41
    s_nop 0
    v_add_f32 v41, 1.0, v41
    v_rcp_f32 v41, v41
    s_nop 0
    v_mul_f32 v41, v40, v41
    v_cvt_pk_bf16_f32 v35, 0, v41
    v_lshlrev_b32 v7, 3, v7
    ds_write_b64 v7, v[34:35] offset:4224
    s_waitcnt lgkmcnt(0)
    s_branch L_tail
L_H2:
    v_and_b32 v7, 7, v0
    v_mul_u32_u24 v38, 37, v7
    v_add_u32 v38, s74, v38
    v_and_b32 v38, 0xff, v38
    v_and_b32 v7, 31, v0
    v_lshlrev_b32 v7, 2, v7
    v_and_b32 v6, 1, v0
    v_cmp_eq_u32 s[64:65], 1, v6
    s_nop 4
L_ml:
    ds_read_b64 v[28:29], v9
    s_waitcnt lgkmcnt(0)
    v_max_u32 v30, v28, v29
    v_cmp_eq_u32 vcc, -1, v30
    s_nop 4
    s_cbranch_vccz L_ml_ok
    s_sleep 8
    s_sub_u32 s62, s62, 1
    s_cmp_gt_i32 s62, 0
    s_cbranch_scc1 L_ml
L_ml_ok:
    v_max_f32_dpp v30, v28, v28 quad_perm:[1,0,3,2] row_mask:0xf bank_mask:0xf
    s_nop 1
    v_max_f32_dpp v30, v30, v30 quad_perm:[2,3,0,1] row_mask:0xf bank_mask:0xf
    v_and_b32 v30, s75, v30
    v_sub_f32 v31, v28, v30
    v_mul_f32 v31, 0x3fb8aa3b, v31
    v_exp_f32 v31, v31
    s_nop 0
    v_mul_f32 v31, v31, v29
    s_nop 1
    v_add_f32_dpp v31, v31, v31 quad_perm:[1,0,3,2] row_mask:0xf bank_mask:0xf
    s_nop 1
    v_add_f32_dpp v31, v31, v31 quad_perm:[2,3,0,1] row_mask:0xf bank_mask:0xf
    v_and_b32 v31, s75, v31
    v_cndmask_b32 v36, v30, v31, s[64:65]
    v_or_b32 v36, v36, v38
    s_lshr_b32 s45, s33, 5
    s_mov_b32 exec_hi, 0
    s_mov_b32 exec_lo, 0xffffffff
    buffer_store_dword v36, v7, s[52:55], s45 offen offset:3072 sc1
    s_mov_b64 exec, -1
    s_xor_b32 s45, s45, 128
    s_add_u32 m0, s34, 6144
    s_mov_b32 s63, 90112
    buffer_load_dwordx4 v37, s[48:51], s63 offen  lds
    s_add_u32 m0, s34, 7168
    s_mov_b32 s63, 94208
    buffer_load_dwordx4 v37, s[48:51], s63 offen  lds
    s_waitcnt vmcnt(1) lgkmcnt(0)
    s_add_u32 m0, s34, 0
    s_mov_b32 s63, 98304
    buffer_load_dwordx4 v37, s[48:51], s63 offen  lds
    s_waitcnt vmcnt(1) lgkmcnt(0)
    s_add_u32 m0, s34, 1024
    s_mov_b32 s63, 102400
    buffer_load_dwordx4 v37, s[48:51], s63 offen  lds
    ds_read_b64_tr_b16 v[194:195], v3 offset:4096
    ds_read_b64_tr_b16 v[202:203], v3 offset:4128
    ds_read_b64_tr_b16 v[210:211], v3 offset:4160
    ds_read_b64_tr_b16 v[218:219], v3 offset:4192
    ds_read_b64_tr_b16 v[226:227], v3 offset:4224
    ds_read_b64_tr_b16 v[234:235], v3 offset:4256
    ds_read_b64_tr_b16 v[242:243], v3 offset:4288
    ds_read_b64_tr_b16 v[250:251], v3 offset:4320
    s_waitcnt vmcnt(1) lgkmcnt(0)
    s_add_u32 m0, s34, 2048
    s_mov_b32 s63, 106496
    buffer_load_dwordx4 v37, s[48:51], s63 offen  lds
    s_waitcnt vmcnt(1) lgkmcnt(0)
    s_add_u32 m0, s34, 3072
    s_mov_b32 s63, 110592
    buffer_load_dwordx4 v37, s[48:51], s63 offen  lds
    s_waitcnt vmcnt(1) lgkmcnt(0)
    s_add_u32 m0, s34, 4096
    s_mov_b32 s63, 114688
    buffer_load_dwordx4 v37, s[48:51], s63 offen  lds
    s_waitcnt vmcnt(1) lgkmcnt(0)
    s_add_u32 m0, s34, 5120
    s_mov_b32 s63, 118784
    buffer_load_dwordx4 v37, s[48:51], s63 offen  lds
    ds_read_b64_tr_b16 v[196:197], v3 offset:0
    ds_read_b64_tr_b16 v[204:205], v3 offset:32
    ds_read_b64_tr_b16 v[212:213], v3 offset:64
    ds_read_b64_tr_b16 v[220:221], v3 offset:96
    ds_read_b64_tr_b16 v[228:229], v3 offset:128
    ds_read_b64_tr_b16 v[236:237], v3 offset:160
    ds_read_b64_tr_b16 v[244:245], v3 offset:192
    ds_read_b64_tr_b16 v[252:253], v3 offset:224
    s_waitcnt vmcnt(1) lgkmcnt(0)
    s_add_u32 m0, s34, 6144
    s_mov_b32 s63, 122880
    buffer_load_dwordx4 v37, s[48:51], s63 offen  lds
    s_waitcnt vmcnt(1) lgkmcnt(0)
    s_add_u32 m0, s34, 7168
    s_mov_b32 s63, 126976
    buffer_load_dwordx4 v37, s[48:51], s63 offen  lds
    s_waitcnt vmcnt(0)
    ds_read_b64_tr_b16 v[198:199], v3 offset:4096
    ds_read_b64_tr_b16 v[206:207], v3 offset:4128
    ds_read_b64_tr_b16 v[214:215], v3 offset:4160
    ds_read_b64_tr_b16 v[222:223], v3 offset:4192
    ds_read_b64_tr_b16 v[230:231], v3 offset:4224
    ds_read_b64_tr_b16 v[238:239], v3 offset:4256
    ds_read_b64_tr_b16 v[246:247], v3 offset:4288
    ds_read_b64_tr_b16 v[254:255], v3 offset:4320
    s_waitcnt lgkmcnt(0)
L_pm:
    buffer_load_dword v40, v7, s[52:55], s45 offen offset:3072 sc1
    s_waitcnt vmcnt(0)
    v_xor_b32 v40, v40, v38
    v_and_b32 v41, 0xff, v40
    v_cmp_ne_u32 vcc, 0, v41
    s_nop 4
    s_cbranch_vccz L_pm_ok
    s_sleep 8
    s_sub_u32 s62, s62, 1
    s_cmp_gt_i32 s62, 0
    s_cbranch_scc1 L_pm
L_pm_ok:
    v_mov_b32_dpp v36, v40 quad_perm:[0,0,0,0] row_mask:0xf bank_mask:0xf
    v_mov_b32_dpp v39, v40 quad_perm:[1,1,1,1] row_mask:0xf bank_mask:0xf
    v_max_f32 v41, v30, v36
    v_sub_f32 v30, v30, v41
    v_sub_f32 v36, v36, v41
    v_sub_f32 v28, v28, v41
    v_mul_f32 v30, 0x3fb8aa3b, v30
    v_mul_f32 v36, 0x3fb8aa3b, v36
    v_mul_f32 v28, 0x3fb8aa3b, v28
    v_exp_f32 v30, v30
    v_exp_f32 v36, v36
    v_exp_f32 v28, v28
    v_mul_f32 v31, v31, v30
    v_mul_f32 v39, v39, v36
    v_add_f32 v31, v31, v39
    v_rcp_f32 v31, v31
    s_nop 0
    v_mul_f32 v28, v28, v31
    v_and_b32 v29, 3, v0
    v_lshlrev_b32 v29, 2, v29
    ds_write_b32 v29, v28 offset:4160
    s_waitcnt lgkmcnt(0)
L_tail:
    v_and_b32 v6, 3, v0
    v_mul_u32_u24 v6, 272, v6
    v_lshl_add_u32 v6, v1, 5, v6
    v_bfe_u32 v7, v0, 2, 1
    v_lshl_add_u32 v6, v7, 4, v6
    v_mov_b32 v12, 0x44444444
    v_mov_b32 v4, 0xeeeeeeee
    v_cmp_eq_u32 vcc, 1, v7
    s_nop 1
    v_cndmask_b32 v12, v12, v4, vcc
    v_mov_b32 v4, 1088
    v_cmp_gt_u32 vcc, 8, v2
    s_nop 1
    v_cndmask_b32 v3, v4, v6, vcc
    v_cndmask_b32 v9, v6, v4, vcc
    v_and_b32 v7, 7, v0
    v_mul_u32_u24 v38, 37, v7
    v_add_u32 v38, s74, v38
    v_and_b32 v38, 0xff, v38
    v_mov_b32 v4, 0
    s_mul_i32 s46, s35, 512
    v_lshl_add_u32 v8, v0, 2, s46
    v_add_u32 v63, 256, v8
    s_lshr_b32 s63, s33, 12
    s_mul_i32 s63, s63, 2048
    s_add_u32 s63, s63, 1310720
    s_mov_b32 s40, s22
    s_and_b32 s41, s23, 0xffff
    s_mov_b32 s42, 4096
    s_mov_b32 s43, 0x20000
    v_lshl_add_u32 v62, v0, 4, s46
    s_mov_b32 s47, 0
    s_cmp_lg_u32 s35, 1
    s_cbranch_scc1 L_t1
    s_mov_b32 s47, 1
    s_mov_b32 s54, 0
    s_mov_b32 s42, 0
    s_mov_b32 s45, s62
    s_mov_b32 s62, 0
L_t1:
    v_mov_b32 v96, 0
    v_mov_b32 v97, 0
    v_mov_b32 v98, 0
    v_mov_b32 v99, 0
    v_mov_b32 v100, 0
    v_mov_b32 v101, 0
    v_mov_b32 v102, 0
    v_mov_b32 v103, 0
    v_mov_b32 v104, 0
    v_mov_b32 v105, 0
    v_mov_b32 v106, 0
    v_mov_b32 v107, 0
    v_mov_b32 v108, 0
    v_mov_b32 v109, 0
    v_mov_b32 v110, 0
    v_mov_b32 v111, 0
    s_cmp_lg_u32 s47, 0
    s_cbranch_scc1 L_t2
    s_barrier
L_t2:
    ds_read_b128 v[64:67], v3 offset:2048
    ds_read_b128 v[68:71], v9 offset:2048
    ds_read_b128 v[72:75], v3 offset:2176
    ds_read_b128 v[76:79], v9 offset:2176
    ds_read_b128 v[28:31], v4 offset:4160
    s_waitcnt lgkmcnt(4)
    v_smfmac_f32_16x16x64_bf16 v[96:99], v[64:67], v[128:135], v12
    s_waitcnt lgkmcnt(3)
    v_smfmac_f32_16x16x64_bf16 v[96:99], v[68:71], v[144:151], v12
    s_waitcnt lgkmcnt(2)
    v_smfmac_f32_16x16x64_bf16 v[96:99], v[72:75], v[192:199], v12
    s_waitcnt lgkmcnt(1)
    v_smfmac_f32_16x16x64_bf16 v[96:99], v[76:79], v[208:215], v12
    s_waitcnt lgkmcnt(0)
    v_smfmac_f32_16x16x64_bf16 v[100:103], v[64:67], v[136:143], v12
    v_smfmac_f32_16x16x64_bf16 v[100:103], v[68:71], v[152:159], v12
    v_smfmac_f32_16x16x64_bf16 v[100:103], v[72:75], v[200:207], v12
    v_smfmac_f32_16x16x64_bf16 v[100:103], v[76:79], v[216:223], v12
    v_smfmac_f32_16x16x64_bf16 v[104:107], v[64:67], v[160:167], v12
    v_smfmac_f32_16x16x64_bf16 v[104:107], v[68:71], v[176:183], v12
    v_smfmac_f32_16x16x64_bf16 v[104:107], v[72:75], v[224:231], v12
    v_smfmac_f32_16x16x64_bf16 v[104:107], v[76:79], v[240:247], v12
    v_smfmac_f32_16x16x64_bf16 v[108:111], v[64:67], v[168:175], v12
    v_smfmac_f32_16x16x64_bf16 v[108:111], v[68:71], v[184:191], v12
    v_smfmac_f32_16x16x64_bf16 v[108:111], v[72:75], v[232:239], v12
    v_smfmac_f32_16x16x64_bf16 v[108:111], v[76:79], v[248:255], v12
    v_mul_f32 v16, v28, v96
    v_fmac_f32 v16, v29, v97
    v_fmac_f32 v16, v30, v98
    v_fmac_f32 v16, v31, v99
    v_mul_f32 v17, v28, v100
    v_fmac_f32 v17, v29, v101
    v_fmac_f32 v17, v30, v102
    v_fmac_f32 v17, v31, v103
    s_nop 1
    v_permlane16_swap_b32 v16, v17
    v_add_f32 v10, v16, v17
    v_and_or_b32 v10, v10, s75, v38
    buffer_store_dword v10, v8, s[52:55], s63 offen sc1
    v_mul_f32 v18, v28, v104
    v_fmac_f32 v18, v29, v105
    v_fmac_f32 v18, v30, v106
    v_fmac_f32 v18, v31, v107
    v_mul_f32 v19, v28, v108
    v_fmac_f32 v19, v29, v109
    v_fmac_f32 v19, v30, v110
    v_fmac_f32 v19, v31, v111
    s_nop 1
    v_permlane16_swap_b32 v18, v19
    v_add_f32 v11, v18, v19
    v_and_or_b32 v11, v11, s75, v38
    buffer_store_dword v11, v63, s[52:55], s63 offen sc1
    s_cmp_eq_u32 s47, 0
    s_cbranch_scc1 L_done
L_fin:
    v_and_b32 v7, 7, v0
    v_lshlrev_b32 v6, 3, v7
    ds_read_b64 v[32:33], v6 offset:4224
    v_lshrrev_b32 v36, 3, v0
    s_lshl_b32 s44, s28, 7
    s_and_b32 s46, s29, 7
    s_lshl_b32 s46, s46, 4
    s_add_u32 s46, s46, s44
    s_lshr_b32 s44, s29, 3
    s_lshl_b32 s72, s44, 10
    s_add_u32 s72, s72, s46
    s_mul_i32 s64, s44, 131072
    s_add_u32 s64, s64, 1310720
    v_mul_u32_u24 v35, 2048, v36
    v_lshl_add_u32 v35, v7, 2, v35
    s_and_b32 s73, s29, 7
    s_lshl_b32 s73, s73, 5
    s_mul_i32 s46, s28, 256
    s_add_u32 s73, s73, s46
    v_add_u32 v35, s73, v35
    s_add_u32 s65, s64, 16384
    s_add_u32 s66, s65, 16384
    s_add_u32 s67, s66, 16384
    s_add_u32 s68, s67, 16384
    s_add_u32 s69, s68, 16384
    s_add_u32 s70, s69, 16384
    s_add_u32 s71, s70, 16384
    v_mul_u32_u24 v38, 37, v7
    v_add_u32 v38, s74, v38
    v_and_b32 v38, 0xff, v38
    v_lshlrev_b32 v34, 1, v7
    v_mov_b32 v29, 0
    s_waitcnt lgkmcnt(0)
    s_nop 0
L_poll:
    buffer_load_dword v40, v35, s[52:55], s64 offen sc1
    buffer_load_dword v41, v35, s[52:55], s65 offen sc1
    buffer_load_dword v42, v35, s[52:55], s66 offen sc1
    buffer_load_dword v43, v35, s[52:55], s67 offen sc1
    buffer_load_dword v44, v35, s[52:55], s68 offen sc1
    buffer_load_dword v45, v35, s[52:55], s69 offen sc1
    buffer_load_dword v46, v35, s[52:55], s70 offen sc1
    buffer_load_dword v47, v35, s[52:55], s71 offen sc1
    s_waitcnt vmcnt(7)
    v_xor_b32 v40, v40, v38
    s_waitcnt vmcnt(6)
    v_xor_b32 v41, v41, v38
    v_or_b32 v28, v40, v41
    v_add_f32 v40, v40, v41
    s_waitcnt vmcnt(5)
    v_xor_b32 v42, v42, v38
    v_or_b32 v28, v28, v42
    v_add_f32 v40, v40, v42
    s_waitcnt vmcnt(4)
    v_xor_b32 v43, v43, v38
    v_or_b32 v28, v28, v43
    v_add_f32 v40, v40, v43
    s_waitcnt vmcnt(3)
    v_xor_b32 v44, v44, v38
    v_or_b32 v28, v28, v44
    v_add_f32 v40, v40, v44
    s_waitcnt vmcnt(2)
    v_xor_b32 v45, v45, v38
    v_or_b32 v28, v28, v45
    v_add_f32 v40, v40, v45
    s_waitcnt vmcnt(1)
    v_xor_b32 v46, v46, v38
    v_or_b32 v28, v28, v46
    v_add_f32 v40, v40, v46
    s_waitcnt vmcnt(0)
    v_xor_b32 v47, v47, v38
    v_or_b32 v28, v28, v47
    v_cmp_ne_u32_sdwa vcc, v28, v29 src0_sel:BYTE_0 src1_sel:DWORD
    v_add_f32 v40, v40, v47
    s_cbranch_vccz L_poll_ok
    s_sub_u32 s62, s62, 1
    s_cmp_gt_i32 s62, 0
    s_cbranch_scc1 L_poll
L_poll_ok:
    s_nop 0
    v_add_f32_dpp v40, v40, v40 row_ror:8 row_mask:0xf bank_mask:0xf
    v_mov_b32 v41, v40
    s_nop 1
    v_permlane16_swap_b32 v40, v41
    v_add_f32 v40, v40, v41
    v_mov_b32 v41, v40
    s_nop 1
    v_permlane32_swap_b32 v40, v41
    v_add_f32 v40, v40, v41
    v_cvt_pk_bf16_f32 v40, 0, v40
    v_mul_f32 v40, v40, v33
    v_cvt_pk_bf16_f32 v40, 0, v40
    v_add_f32 v40, v40, v32
    v_cvt_pk_bf16_f32 v40, v40, v40
    s_mov_b64 exec, 0xff
    buffer_store_short v40, v34, s[40:43], s72 offen
    s_cmp_eq_u32 s47, 0
    s_cbranch_scc1 L_done
    s_waitcnt vmcnt(0) lgkmcnt(0)
    s_mov_b32 s47, 0
    s_mov_b32 s54, 33554432
    s_mov_b32 s42, 4096
    s_mov_b32 s62, s45
    s_mov_b64 exec, -1
    s_branch L_t1
L_done:
L_end:
    s_endpgm
.section .rodata,"a"
.p2align 6
.amdhsa_kernel recurrent_scan__mha_block_cached__glu_gated_reglu__decode_kernel
  .amdhsa_next_free_vgpr 256
  .amdhsa_next_free_sgpr 102
  .amdhsa_accum_offset 256
  .amdhsa_group_segment_fixed_size 0
  .amdhsa_kernarg_size 96
  .amdhsa_user_sgpr_count 2
  .amdhsa_user_sgpr_kernarg_segment_ptr 1
  .amdhsa_system_sgpr_workgroup_id_x 1
.end_amdhsa_kernel
```
